```python
import torch

def _softmax(x, axis=-1):
    return torch.softmax(x, dim=axis)
def _gelu(x):
    return torch.nn.functional.gelu(x, approximate="tanh")
def _silu(x):
    return torch.nn.functional.silu(x)
def _sigmoid(x):
    return torch.sigmoid(x)
def _layernorm(x, axis=-1, eps=1e-5):
    m = x.mean(dim=axis, keepdim=True)
    v = x.var(dim=axis, keepdim=True, unbiased=False)
    return (x - m) / torch.sqrt(v + eps)
def _scatter_add(tgt, idx, src, axis=0):
    return tgt.clone().index_add_(axis, idx, src)
def _segment_sum(src, seg, n):
    out = torch.zeros((n,) + src.shape[1:], dtype=src.dtype)
    return out.index_add_(0, seg, src)
def _pad(x, pw):
    flat = tuple(v for pair in reversed(pw) for v in pair)
    return torch.nn.functional.pad(x, flat)

kernel_name = 'gated_mix__mha_block_cached__dense_activation_mish__decode'

def setup_inputs():

    _w = (lambda a: (lambda t: t.to(torch.bfloat16) if t.is_floating_point() else t)(torch.as_tensor(a)))
    def _A_setup():
        B, Sq, D = 2, 1, 576
        H, Sk, Dh = 32, 8192, 128
        return {
            "x": _w((lambda *s: torch.randn(*s, dtype=torch.bfloat16) * 0.05)(B, Sq, D)),
            "k_cache": _w((lambda *s: torch.randn(*s, dtype=torch.bfloat16) * 6.4)(B, H, Sk, Dh)),
            "v_cache": _w((lambda *s: torch.randn(*s, dtype=torch.bfloat16) * 0.2)(B, H, Sk, Dh)),
            "wq": _w((lambda *s: torch.randn(*s, dtype=torch.bfloat16) * 6.4)(D, H * Dh) * (D ** -0.5)),
            "wo": _w((lambda *s: torch.randn(*s, dtype=torch.bfloat16) * 0.2)(H * Dh, D) * ((H * Dh) ** -0.5)),
        }
    _A_in = _A_setup()

    def _B_setup():
        B, S, D, F = 2, 1, 576, 4608
        return {
            "x": _w((lambda *s: torch.randn(*s, dtype=torch.bfloat16) * 0.05)(B, S, D)),
            "w1": _w((lambda *s: torch.randn(*s, dtype=torch.bfloat16) * 3.2)(D, F) * (D ** -0.5)),
            "b1": _w((lambda *s: torch.randn(*s, dtype=torch.bfloat16) * 0.05)(F)),
            "w2": _w((lambda *s: torch.randn(*s, dtype=torch.bfloat16) * 0.05)(F, D) * (F ** -0.5)),
        }
    _B_in = _B_setup()

    return {
        "A_x": _A_in["x"],
        "A_k_cache": _A_in["k_cache"],
        "A_v_cache": _A_in["v_cache"],
        "A_wq": _A_in["wq"],
        "A_wo": _A_in["wo"],
        "B_x": _B_in["x"],
        "B_w1": _B_in["w1"],
        "B_b1": _B_in["b1"],
        "B_w2": _B_in["w2"],
        "gate_w": _w((lambda *s: torch.randn(*s, dtype=torch.bfloat16) * 0.05)(576) * 16.0),
    }

def reference(A_x, A_k_cache, A_v_cache, A_wq, A_wo, B_x, B_w1, B_b1, B_w2, gate_w):
    def _A_ref(x, k_cache, v_cache, wq, wo):
        B, Sq, D = x.shape
        H, Dh = 32, 128
        q = (lambda x, *d: x.permute(*d))((x @ wq).reshape(B, Sq, H, Dh), 0, 2, 1, 3)
        scores = torch.einsum("bhqd,bhkd->bhqk", q, k_cache) * (Dh ** -0.5)
        p = _softmax(scores, axis=-1)
        o = torch.einsum("bhqk,bhkd->bhqd", p, v_cache)
        return (lambda x, *d: x.permute(*d))(o, 0, 2, 1, 3).reshape(B, Sq, H * Dh) @ wo

    def _B_ref(x, w1, b1, w2):
        h = torch.einsum("bsd,df->bsf", x, w1) + b1
        sp = torch.log1p(torch.exp(-torch.abs(h))) + torch.where(h > 0, h, torch.zeros_like(h))
        act = h * torch.tanh(sp)
        return torch.einsum("bsf,fd->bsd", act, w2)

    x = A_x
    g = _sigmoid((x * gate_w).sum(-1, keepdims=True))
    a = _A_ref(x, A_k_cache, A_v_cache, A_wq, A_wo)
    b = _B_ref(x, B_w1, B_b1, B_w2)
    return g * a + (1 - g) * b
```

```asm
; @launch grid=(256,1,1) block=(256,1,1) lds=69632
.amdgcn_target "amdgcn-amd-amdhsa--gfx950"
.text
.globl gated_mix__mha_block_cached__dense_activation_mish__decode_kernel
.p2align 8
.type gated_mix__mha_block_cached__dense_activation_mish__decode_kernel,@function
gated_mix__mha_block_cached__dense_activation_mish__decode_kernel:
  s_cmpk_ge_u32 s2, 256
  s_cbranch_scc1 L_end
  s_load_dwordx16 s[4:19], s[0:1], 0
  s_load_dwordx8 s[20:27], s[0:1], 64
  v_readfirstlane_b32 s30, v0
  s_lshr_b32 s32, s2, 3
  s_and_b32 s31, s2, 7
  s_mov_b32 s39, 0x20000
  s_cmp_lt_u32 s30, 64
  s_cbranch_scc0 L_helper
  v_lshlrev_b32 v2, 4, v0
  s_mov_b32 s43, 0xc0808080
  s_bfm_b32 s3, s32, 0
  s_and_b32 s3, s3, s43
  s_bcnt1_i32_b32 s3, s3
  s_mul_i32 s42, s32, 12
  s_mul_i32 s3, s3, 39
  s_add_u32 s42, s42, s3
  s_bitcmp1_b32 s43, s32
  s_cselect_b32 s43, 51, 12
  s_add_u32 s43, s43, s42
  s_lshl_b32 s43, s43, 10
  s_lshl_b32 s42, s42, 10
  s_mov_b32 s38, 589824
  s_mul_i32 s3, s31, s38
  s_waitcnt lgkmcnt(0)
  s_add_u32 s36, s12, s3
  s_addc_u32 s37, s13, 0
L_aloop:
  s_waitcnt vmcnt(14)
  buffer_load_dwordx4 v[48:51], v2, s[36:39], s42 offen offset:0
  s_waitcnt vmcnt(14)
  buffer_load_dwordx4 v[48:51], v2, s[36:39], s42 offen offset:1024
  s_waitcnt vmcnt(14)
  buffer_load_dwordx4 v[48:51], v2, s[36:39], s42 offen offset:2048
  s_addk_i32 s42, 3072
  s_cmp_lt_u32 s42, s43
  s_cbranch_scc1 L_aloop
  s_branch L_stream
L_helper:
  s_lshr_b32 s47, s32, 3
  s_lshl2_add_u32 s33, s31, s47
  s_lshr_b32 s34, s32, 2
  s_and_b32 s34, s34, 1
  s_and_b32 s35, s32, 3
  s_lshl_b32 s3, s34, 5
  s_add_u32 s3, s3, s33
  s_load_dwordx2 s[28:29], s[0:1], 96
  s_lshr_b32 s30, s30, 6
  v_and_b32 v0, 63, v0
  s_lshl2_add_u32 s44, s3, s35
  s_cmp_eq_u32 s30, 3
  s_cbranch_scc0 L_nopf
  s_getpc_b64 s[48:49]
L_pc:
  s_mov_b32 s50, L_codeend-L_pc
  s_mov_b32 s51, 0x20000
  s_lshl_b32 s3, s32, 7
  v_lshl_add_u32 v6, v0, 12, s3
  buffer_load_dword v64, v6, s[48:51], 0 offen
L_nopf:
  v_lshrrev_b32 v6, 4, v0
  v_and_b32 v7, 15, v0
  v_bfe_u32 v5, v0, 3, 1
  s_mov_b32 s54, 2304
  s_mov_b32 s55, 0x20000
  s_mov_b32 s59, 0x20000
  s_cmp_eq_u32 s30, 1
  s_cbranch_scc0 L_noq
  v_lshlrev_b32 v1, 13, v6
  v_lshl_add_u32 v1, v7, 4, v1
  v_mul_u32_u24 v2, 1152, v5
  s_and_b32 s43, s32, 7
  s_mul_i32 s47, s43, 144
  s_mul_i32 s3, s43, 589824
  s_lshl_b32 s52, s33, 8
  s_add_u32 s3, s3, s52
  s_sub_u32 s38, 4718592, s3
  s_mov_b32 s42, 0
  s_mov_b32 s45, 0x8000
  s_waitcnt lgkmcnt(0)
  s_load_dword s80, s[28:29], 753664
  s_mov_b32 s52, s4
  s_mov_b32 s53, s5
  s_add_u32 s36, s10, s3
  s_addc_u32 s37, s11, 0
  buffer_load_dwordx4 v[64:67], v2, s[52:55], s47 offen offset:0
  buffer_load_dwordx4 v[68:71], v2, s[52:55], s47 offen offset:16
  buffer_load_dwordx4 v[72:75], v2, s[52:55], s47 offen offset:32
  buffer_load_dwordx4 v[76:79], v2, s[52:55], s47 offen offset:48
  buffer_load_dwordx4 v[80:83], v2, s[52:55], s47 offen offset:64
  buffer_load_dwordx4 v[84:87], v2, s[52:55], s47 offen offset:80
  buffer_load_dwordx4 v[88:91], v2, s[52:55], s47 offen offset:96
  buffer_load_dwordx4 v[92:95], v2, s[52:55], s47 offen offset:112
  buffer_load_dwordx4 v[96:99], v2, s[52:55], s47 offen offset:128
  buffer_load_dwordx4 a[0:3], v1, s[36:39], s42 offen nt
  s_add_u32 s42, s42, s45
  buffer_load_dwordx4 a[4:7], v1, s[36:39], s42 offen nt
  s_add_u32 s42, s42, s45
  buffer_load_dwordx4 a[8:11], v1, s[36:39], s42 offen nt
  s_add_u32 s42, s42, s45
  buffer_load_dwordx4 a[12:15], v1, s[36:39], s42 offen nt
  s_add_u32 s42, s42, s45
  buffer_load_dwordx4 a[16:19], v1, s[36:39], s42 offen nt
  s_add_u32 s42, s42, s45
  buffer_load_dwordx4 a[20:23], v1, s[36:39], s42 offen nt
  s_add_u32 s42, s42, s45
  s_waitcnt vmcnt(5)
  buffer_load_dwordx4 a[24:27], v1, s[36:39], s42 offen nt
  s_add_u32 s42, s42, s45
  s_waitcnt vmcnt(5)
  buffer_load_dwordx4 a[28:31], v1, s[36:39], s42 offen nt
  s_add_u32 s42, s42, s45
  s_waitcnt vmcnt(5)
  buffer_load_dwordx4 a[32:35], v1, s[36:39], s42 offen nt
  s_add_u32 s42, s42, s45
  s_waitcnt vmcnt(5)
  buffer_load_dwordx4 a[36:39], v1, s[36:39], s42 offen nt
  s_add_u32 s42, s42, s45
  s_waitcnt vmcnt(5)
  buffer_load_dwordx4 a[40:43], v1, s[36:39], s42 offen nt
  s_add_u32 s42, s42, s45
  s_waitcnt vmcnt(5)
  buffer_load_dwordx4 a[44:47], v1, s[36:39], s42 offen nt
  s_add_u32 s42, s42, s45
  s_waitcnt vmcnt(5)
  buffer_load_dwordx4 a[48:51], v1, s[36:39], s42 offen nt
  s_add_u32 s42, s42, s45
  s_waitcnt vmcnt(5)
  buffer_load_dwordx4 a[52:55], v1, s[36:39], s42 offen nt
  s_add_u32 s42, s42, s45
  s_waitcnt vmcnt(5)
  buffer_load_dwordx4 a[56:59], v1, s[36:39], s42 offen nt
  s_add_u32 s42, s42, s45
  s_waitcnt vmcnt(5)
  buffer_load_dwordx4 a[60:63], v1, s[36:39], s42 offen nt
  s_add_u32 s42, s42, s45
  s_waitcnt vmcnt(5)
  buffer_load_dwordx4 a[64:67], v1, s[36:39], s42 offen nt
  s_add_u32 s42, s42, s45
  s_waitcnt vmcnt(5)
  buffer_load_dwordx4 a[68:71], v1, s[36:39], s42 offen nt
  s_branch L_h0b
L_stream:
  s_lshr_b32 s47, s32, 3
  s_and_b32 s83, s31, 1
  s_mul_i32 s83, s83, 3
  s_add_u32 s83, s83, s47
  s_lshl2_add_u32 s47, s31, s47
  s_lshr_b32 s81, s31, 1
  s_add_u32 s81, s81, 32
  s_and_b32 s3, s32, 7
  s_cmp_lt_u32 s3, 6
  s_cselect_b32 s83, s3, s83
  s_cselect_b32 s81, s47, s81
  s_bitcmp1_b32 0xc0808080, s32
  s_cselect_b32 s83, 7, s83
  s_cbranch_scc1 L_notile
  v_lshrrev_b32 v6, 4, v0
  s_movk_i32 m0, 16384
  s_mov_b32 s42, 0
  s_cmp_lt_u32 s83, 3
  s_cbranch_scc0 L_tile2
  v_and_b32 v7, 15, v0
  v_mul_u32_u24 v1, 9216, v6
  v_lshl_add_u32 v1, v7, 4, v1
  s_lshl_b32 s3, s81, 8
  s_mul_i32 s47, s83, 1769472
  s_add_u32 s3, s3, s47
  s_add_u32 s36, s16, s3
  s_addc_u32 s37, s17, 0
  s_sub_u32 s38, 5308416, s3
  s_mov_b32 s46, 36864
  s_mov_b32 s47, s46
  s_branch L_tloop
L_tile2:
  v_bfe_u32 v7, v0, 3, 1
  v_lshl_add_u32 v1, v7, 2, v6
  v_mul_u32_u24 v1, 1152, v1
  v_and_b32 v7, 7, v0
  v_lshl_add_u32 v1, v7, 4, v1
  s_mul_i32 s3, s81, 147456
  s_mul_i32 s47, s83, 384
  s_add_u32 s3, s3, s47
  s_sub_u32 s3, s3, 1152
  s_add_u32 s36, s20, s3
  s_addc_u32 s37, s21, 0
  s_sub_u32 s38, 5308416, s3
  s_movk_i32 s46, 128
  s_movk_i32 s47, 8960
L_tloop:
  s_waitcnt vmcnt(14)
  buffer_load_dwordx4 v1, s[36:39], s42 offen nt lds
  s_addk_i32 m0, 1024
  s_add_u32 s42, s42, s46
  s_waitcnt vmcnt(14)
  buffer_load_dwordx4 v1, s[36:39], s42 offen nt lds
  s_addk_i32 m0, 1024
  s_add_u32 s42, s42, s46
  s_waitcnt vmcnt(14)
  buffer_load_dwordx4 v1, s[36:39], s42 offen nt lds
  s_addk_i32 m0, 1024
  s_add_u32 s42, s42, s47
  s_cmp_lt_u32 m0, 65536
  s_cbranch_scc1 L_tloop
L_notile:
  s_lshr_b32 s47, s32, 3
  s_lshl2_add_u32 s33, s31, s47
  s_lshr_b32 s34, s32, 2
  s_and_b32 s34, s34, 1
  s_and_b32 s35, s32, 3
  s_lshl_b32 s3, s34, 5
  s_add_u32 s3, s3, s33
  v_and_b32 v3, 3, v0
  v_and_b32 v1, 12, v0
  v_lshl_add_u32 v1, v1, 2, v3
  v_lshrrev_b32 v6, 4, v0
  v_lshl_add_u32 v1, v6, 2, v1
  v_lshlrev_b32 v1, 4, v1
  s_lshl_b32 s3, s3, 5
  s_add_u32 s3, s3, s35
  s_lshl_b32 s3, s3, 16
  s_mov_b32 s38, 0x1d0000
  s_mul_i32 s42, s34, 8
  s_mul_i32 s47, s47, 1
  s_add_u32 s42, s42, s47
  s_mul_i32 s46, s31, 11
  s_add_u32 s42, s42, s46
  s_and_b32 s46, s42, 1
  s_and_b32 s42, s42, 14
  s_lshl2_add_u32 s42, s42, s46
  s_lshl_b32 s42, s42, 15
  s_movk_i32 s46, 0x1000
  s_add_u32 s36, s6, s3
  s_addc_u32 s37, s7, 0
  s_waitcnt vmcnt(19)
  buffer_load_dwordx4 a[0:3], v1, s[36:39], s42 offen offset:0 nt
  s_load_dwordx2 s[28:29], s[0:1], 96
  s_add_u32 s40, s8, s3
  s_addc_u32 s41, s9, 0
  v_lshl_add_u32 v44, v6, 2, v3
  v_lshlrev_b32 v44, 4, v44
  s_waitcnt vmcnt(19)
  buffer_load_dwordx4 a[4:7], v1, s[36:39], s42 offen offset:1024 nt
  v_lshlrev_b32 v4, 1, v6
  v_lshl_add_u32 v4, v3, 4, v4
  v_and_b32 v5, 8, v0
  v_add_u32 v4, v4, v5
  s_waitcnt vmcnt(19)
  buffer_load_dwordx4 a[8:11], v1, s[36:39], s42 offen offset:2048 nt
  v_bfe_u32 v5, v0, 2, 1
  v_add_u32 v4, v4, v5
  v_mul_u32_u24 v8, 0x5555, v3
  v_lshlrev_b32 v4, 2, v4
  s_waitcnt vmcnt(19)
  buffer_load_dwordx4 a[12:15], v1, s[36:39], s42 offen offset:3072 nt
  s_add_u32 s42, s42, s46
  v_add_u32 v4, 64, v4
  v_and_b32 v3, 60, v0
  v_add_u32 v3, 0, v3
  v_mov_b32 v12, 0
  s_waitcnt vmcnt(19)
  buffer_load_dwordx4 a[16:19], v1, s[36:39], s42 offen offset:0 nt
  v_mov_b32 v13, 0
  v_mov_b32 v14, 0
  v_mov_b32 v15, 0
  v_mov_b32 v16, 0
  s_waitcnt vmcnt(19)
  buffer_load_dwordx4 a[20:23], v1, s[36:39], s42 offen offset:1024 nt
  v_mov_b32 v17, 0
  v_mov_b32 v18, 0
  v_mov_b32 v19, 0
  v_mov_b32 v20, 0
  s_waitcnt vmcnt(19)
  buffer_load_dwordx4 a[24:27], v1, s[36:39], s42 offen offset:2048 nt
  v_mov_b32 v21, 0
  v_mov_b32 v22, 0
  v_mov_b32 v23, 0
  v_mov_b32 v24, 0
  s_waitcnt vmcnt(19)
  buffer_load_dwordx4 a[28:31], v1, s[36:39], s42 offen offset:3072 nt
  s_add_u32 s42, s42, s46
  v_mov_b32 v25, 0
  v_mov_b32 v26, 0
  v_mov_b32 v27, 0
  v_mov_b32 v6, 0xff800000
  s_waitcnt vmcnt(19)
  buffer_load_dwordx4 a[32:35], v1, s[36:39], s42 offen offset:0 nt
  v_mov_b32 v32, v6
  v_mov_b32 v33, v6
  v_mov_b32 v34, v6
  v_mov_b32 v35, v6
  s_waitcnt vmcnt(19)
  buffer_load_dwordx4 a[36:39], v1, s[36:39], s42 offen offset:1024 nt
  v_mov_b32 v45, 8768
  ds_write_b64 v45, v[12:13]
  s_mov_b32 s45, 0x3e0293ee
  s_mov_b32 s43, 0
  s_waitcnt vmcnt(19)
  buffer_load_dwordx4 a[40:43], v1, s[36:39], s42 offen offset:2048 nt
  s_waitcnt vmcnt(19)
  buffer_load_dwordx4 a[44:47], v1, s[36:39], s42 offen offset:3072 nt
  s_add_u32 s42, s42, s46
  s_waitcnt vmcnt(19)
  buffer_load_dwordx4 a[48:51], v1, s[36:39], s42 offen offset:0 nt
  s_waitcnt vmcnt(19)
  buffer_load_dwordx4 a[52:55], v1, s[36:39], s42 offen offset:1024 nt
  s_waitcnt vmcnt(19)
  buffer_load_dwordx4 a[56:59], v1, s[36:39], s42 offen offset:2048 nt
  s_waitcnt vmcnt(19)
  buffer_load_dwordx4 a[60:63], v1, s[36:39], s42 offen offset:3072 nt
  s_add_u32 s42, s42, s46
  s_waitcnt vmcnt(19)
  buffer_load_dwordx4 a[64:67], v1, s[36:39], s42 offen offset:0 nt
  s_waitcnt vmcnt(19)
  buffer_load_dwordx4 a[68:71], v1, s[36:39], s42 offen offset:1024 nt
  s_waitcnt vmcnt(19)
  buffer_load_dwordx4 a[72:75], v1, s[36:39], s42 offen offset:2048 nt
  s_waitcnt vmcnt(19)
  buffer_load_dwordx4 a[76:79], v1, s[36:39], s42 offen offset:3072 nt
  s_add_u32 s42, s42, s46
  s_barrier
  s_waitcnt vmcnt(19)
  buffer_load_dwordx4 a[80:83], v1, s[36:39], s42 offen offset:0 nt
  s_waitcnt vmcnt(19)
  buffer_load_dwordx4 a[84:87], v1, s[36:39], s42 offen offset:1024 nt
  s_waitcnt vmcnt(19)
  buffer_load_dwordx4 a[88:91], v1, s[36:39], s42 offen offset:2048 nt
  s_waitcnt vmcnt(19)
  buffer_load_dwordx4 a[92:95], v1, s[36:39], s42 offen offset:3072 nt
  s_add_u32 s42, s42, s46
  s_waitcnt vmcnt(19)
  buffer_load_dwordx4 a[96:99], v1, s[36:39], s42 offen offset:0 nt
  s_waitcnt vmcnt(19)
  buffer_load_dwordx4 a[100:103], v1, s[36:39], s42 offen offset:1024 nt
  s_waitcnt vmcnt(19)
  buffer_load_dwordx4 a[104:107], v1, s[36:39], s42 offen offset:2048 nt
  s_waitcnt vmcnt(19)
  buffer_load_dwordx4 a[108:111], v1, s[36:39], s42 offen offset:3072 nt
  s_add_u32 s42, s42, s46
  s_waitcnt vmcnt(19)
  buffer_load_dwordx4 a[112:115], v1, s[36:39], s42 offen offset:0 nt
  s_waitcnt vmcnt(19)
  buffer_load_dwordx4 a[116:119], v1, s[36:39], s42 offen offset:1024 nt
  s_waitcnt vmcnt(19)
  buffer_load_dwordx4 a[120:123], v1, s[36:39], s42 offen offset:2048 nt
  s_waitcnt vmcnt(19)
  buffer_load_dwordx4 a[124:127], v1, s[36:39], s42 offen offset:3072 nt
  s_add_u32 s42, s42, s46
  s_and_b32 s47, s42, 0x10000
  s_mul_i32 s47, s47, 3
  s_add_u32 s42, s42, s47
  s_and_b32 s42, s42, 0x1fffff
  s_waitcnt vmcnt(19)
  buffer_load_dwordx4 a[128:131], v1, s[36:39], s42 offen offset:0 nt
  s_waitcnt vmcnt(19)
  buffer_load_dwordx4 a[132:135], v1, s[36:39], s42 offen offset:1024 nt
  s_waitcnt vmcnt(19)
  buffer_load_dwordx4 a[136:139], v1, s[36:39], s42 offen offset:2048 nt
  s_waitcnt vmcnt(19)
  buffer_load_dwordx4 a[140:143], v1, s[36:39], s42 offen offset:3072 nt
  s_add_u32 s42, s42, s46
  s_waitcnt vmcnt(19)
  buffer_load_dwordx4 a[144:147], v1, s[36:39], s42 offen offset:0 nt
  s_waitcnt vmcnt(19)
  buffer_load_dwordx4 a[148:151], v1, s[36:39], s42 offen offset:1024 nt
  s_waitcnt vmcnt(19)
  buffer_load_dwordx4 a[152:155], v1, s[36:39], s42 offen offset:2048 nt
  s_waitcnt vmcnt(19)
  buffer_load_dwordx4 a[156:159], v1, s[36:39], s42 offen offset:3072 nt
  s_add_u32 s42, s42, s46
  s_waitcnt vmcnt(19)
  buffer_load_dwordx4 a[160:163], v1, s[36:39], s42 offen offset:0 nt
  s_waitcnt vmcnt(19)
  buffer_load_dwordx4 a[164:167], v1, s[36:39], s42 offen offset:1024 nt
  s_waitcnt vmcnt(19)
  buffer_load_dwordx4 a[168:171], v1, s[36:39], s42 offen offset:2048 nt
  s_waitcnt vmcnt(19)
  buffer_load_dwordx4 a[172:175], v1, s[36:39], s42 offen offset:3072 nt
  s_add_u32 s42, s42, s46
  s_waitcnt vmcnt(19)
  buffer_load_dwordx4 a[176:179], v1, s[36:39], s42 offen offset:0 nt
  s_waitcnt vmcnt(19)
  buffer_load_dwordx4 a[180:183], v1, s[36:39], s42 offen offset:1024 nt
  s_waitcnt vmcnt(19)
  buffer_load_dwordx4 a[184:187], v1, s[36:39], s42 offen offset:2048 nt
  s_waitcnt vmcnt(19)
  buffer_load_dwordx4 a[188:191], v1, s[36:39], s42 offen offset:3072 nt
  s_add_u32 s42, s42, s46
  s_waitcnt vmcnt(19)
  buffer_load_dwordx4 a[192:195], v1, s[36:39], s42 offen offset:0 nt
  s_waitcnt lgkmcnt(0)
  s_barrier
  ds_read_b128 v[56:59], v44 offset:8512
  ds_read_b32 v9, v45 offset:8
  s_waitcnt lgkmcnt(0)
  s_waitcnt vmcnt(19)
  buffer_load_dwordx4 a[196:199], v1, s[36:39], s42 offen offset:1024 nt
  v_mov_b32_dpp v12, v56 quad_perm:[0,1,2,3] row_mask:0xf bank_mask:0x1
  v_mov_b32_dpp v13, v57 quad_perm:[0,1,2,3] row_mask:0xf bank_mask:0x1
  v_mov_b32_dpp v14, v58 quad_perm:[0,1,2,3] row_mask:0xf bank_mask:0x1
  v_mov_b32_dpp v15, v59 quad_perm:[0,1,2,3] row_mask:0xf bank_mask:0x1
  s_waitcnt vmcnt(19)
  buffer_load_dwordx4 a[200:203], v1, s[36:39], s42 offen offset:2048 nt
  v_mov_b32_dpp v16, v56 quad_perm:[0,1,2,3] row_mask:0xf bank_mask:0x2
  v_mov_b32_dpp v17, v57 quad_perm:[0,1,2,3] row_mask:0xf bank_mask:0x2
  v_mov_b32_dpp v18, v58 quad_perm:[0,1,2,3] row_mask:0xf bank_mask:0x2
  v_mov_b32_dpp v19, v59 quad_perm:[0,1,2,3] row_mask:0xf bank_mask:0x2
  s_waitcnt vmcnt(19)
  buffer_load_dwordx4 a[204:207], v1, s[36:39], s42 offen offset:3072 nt
  s_add_u32 s42, s42, s46
  v_mov_b32_dpp v20, v56 quad_perm:[0,1,2,3] row_mask:0xf bank_mask:0x4
  v_mov_b32_dpp v21, v57 quad_perm:[0,1,2,3] row_mask:0xf bank_mask:0x4
  v_mov_b32_dpp v22, v58 quad_perm:[0,1,2,3] row_mask:0xf bank_mask:0x4
  v_mov_b32_dpp v23, v59 quad_perm:[0,1,2,3] row_mask:0xf bank_mask:0x4
  s_waitcnt vmcnt(19)
  buffer_load_dwordx4 a[208:211], v1, s[36:39], s42 offen offset:0 nt
  v_mov_b32_dpp v24, v56 quad_perm:[0,1,2,3] row_mask:0xf bank_mask:0x8
  v_mov_b32_dpp v25, v57 quad_perm:[0,1,2,3] row_mask:0xf bank_mask:0x8
  v_mov_b32_dpp v26, v58 quad_perm:[0,1,2,3] row_mask:0xf bank_mask:0x8
  v_mov_b32_dpp v27, v59 quad_perm:[0,1,2,3] row_mask:0xf bank_mask:0x8
  s_waitcnt vmcnt(19)
  buffer_load_dwordx4 a[212:215], v1, s[36:39], s42 offen offset:1024 nt
  s_waitcnt vmcnt(19)
  buffer_load_dwordx4 a[216:219], v1, s[36:39], s42 offen offset:2048 nt
  s_waitcnt vmcnt(19)
  buffer_load_dwordx4 a[220:223], v1, s[36:39], s42 offen offset:3072 nt
  s_add_u32 s42, s42, s46
  s_waitcnt vmcnt(19)
  buffer_load_dwordx4 a[224:227], v1, s[36:39], s42 offen offset:0 nt
  s_waitcnt vmcnt(19)
  buffer_load_dwordx4 a[228:231], v1, s[36:39], s42 offen offset:1024 nt
  s_waitcnt vmcnt(19)
  buffer_load_dwordx4 a[232:235], v1, s[36:39], s42 offen offset:2048 nt
  s_waitcnt vmcnt(19)
  buffer_load_dwordx4 a[236:239], v1, s[36:39], s42 offen offset:3072 nt
  s_add_u32 s42, s42, s46
.p2align 3
L_kloop:
  v_mfma_f32_16x16x32_bf16 v[28:31], v[12:15], a[0:3], 0
  s_waitcnt vmcnt(19)
  buffer_load_dwordx4 a[240:243], v1, s[36:39], s42 offen offset:0 nt
  v_mfma_f32_16x16x32_bf16 v[28:31], v[16:19], a[4:7], v[28:31]
  s_waitcnt vmcnt(19)
  buffer_load_dwordx4 a[244:247], v1, s[36:39], s42 offen offset:1024 nt
  v_mov_b32_dpp v5, v32 quad_perm:[0,0,0,0] row_mask:0xf bank_mask:0xf
  v_add_f32_dpp v5, v33, v5 quad_perm:[1,1,1,1] row_mask:0xf bank_mask:0xf
  v_mfma_f32_16x16x32_bf16 v[28:31], v[20:23], a[8:11], v[28:31]
  s_waitcnt vmcnt(19)
  buffer_load_dwordx4 a[248:251], v1, s[36:39], s42 offen offset:2048 nt
  v_add_f32_dpp v5, v34, v5 quad_perm:[2,2,2,2] row_mask:0xf bank_mask:0xf
  v_add_f32_dpp v5, v35, v5 quad_perm:[3,3,3,3] row_mask:0xf bank_mask:0xf
  v_mfma_f32_16x16x32_bf16 v[28:31], v[24:27], a[12:15], v[28:31]
  s_waitcnt vmcnt(19)
  buffer_load_dwordx4 a[252:255], v1, s[36:39], s42 offen offset:3072 nt
  v_max_f32 v6, v6, v5
  ds_write_b32 v3, v5 offset:0
  s_add_u32 s42, s42, s46
  s_and_b32 s47, s42, 0x10000
  s_mul_i32 s47, s47, 3
  s_add_u32 s42, s42, s47
  s_and_b32 s42, s42, 0x1fffff
  v_mfma_f32_16x16x32_bf16 v[32:35], v[12:15], a[16:19], 0
  s_cmp_eq_u32 s43, 7
  s_cbranch_scc0 L_knosw
  s_mov_b32 s36, s40
  s_mov_b32 s37, s41
  v_mov_b32 v1, v2
L_knosw:
  s_waitcnt vmcnt(19)
  buffer_load_dwordx4 a[0:3], v1, s[36:39], s42 offen offset:0 nt
  v_mfma_f32_16x16x32_bf16 v[32:35], v[16:19], a[20:23], v[32:35]
  s_waitcnt vmcnt(19)
  buffer_load_dwordx4 a[4:7], v1, s[36:39], s42 offen offset:1024 nt
  v_mov_b32_dpp v5, v28 quad_perm:[0,0,0,0] row_mask:0xf bank_mask:0xf
  v_add_f32_dpp v5, v29, v5 quad_perm:[1,1,1,1] row_mask:0xf bank_mask:0xf
  v_mfma_f32_16x16x32_bf16 v[32:35], v[20:23], a[24:27], v[32:35]
  s_waitcnt vmcnt(19)
  buffer_load_dwordx4 a[8:11], v1, s[36:39], s42 offen offset:2048 nt
  v_add_f32_dpp v5, v30, v5 quad_perm:[2,2,2,2] row_mask:0xf bank_mask:0xf
  v_add_f32_dpp v5, v31, v5 quad_perm:[3,3,3,3] row_mask:0xf bank_mask:0xf
  v_mfma_f32_16x16x32_bf16 v[32:35], v[24:27], a[28:31], v[32:35]
  s_waitcnt vmcnt(19)
  buffer_load_dwordx4 a[12:15], v1, s[36:39], s42 offen offset:3072 nt
  v_max_f32 v6, v6, v5
  ds_write_b32 v3, v5 offset:64
  s_add_u32 s42, s42, s46
  v_mfma_f32_16x16x32_bf16 v[28:31], v[12:15], a[32:35], 0
  s_waitcnt vmcnt(19)
  buffer_load_dwordx4 a[16:19], v1, s[36:39], s42 offen offset:0 nt
  v_mfma_f32_16x16x32_bf16 v[28:31], v[16:19], a[36:39], v[28:31]
  s_waitcnt vmcnt(19)
  buffer_load_dwordx4 a[20:23], v1, s[36:39], s42 offen offset:1024 nt
  v_mov_b32_dpp v5, v32 quad_perm:[0,0,0,0] row_mask:0xf bank_mask:0xf
  v_add_f32_dpp v5, v33, v5 quad_perm:[1,1,1,1] row_mask:0xf bank_mask:0xf
  v_mfma_f32_16x16x32_bf16 v[28:31], v[20:23], a[40:43], v[28:31]
  s_waitcnt vmcnt(19)
  buffer_load_dwordx4 a[24:27], v1, s[36:39], s42 offen offset:2048 nt
  v_add_f32_dpp v5, v34, v5 quad_perm:[2,2,2,2] row_mask:0xf bank_mask:0xf
  v_add_f32_dpp v5, v35, v5 quad_perm:[3,3,3,3] row_mask:0xf bank_mask:0xf
  v_mfma_f32_16x16x32_bf16 v[28:31], v[24:27], a[44:47], v[28:31]
  s_waitcnt vmcnt(19)
  buffer_load_dwordx4 a[28:31], v1, s[36:39], s42 offen offset:3072 nt
  v_max_f32 v6, v6, v5
  ds_write_b32 v3, v5 offset:128
  s_add_u32 s42, s42, s46
  v_mfma_f32_16x16x32_bf16 v[32:35], v[12:15], a[48:51], 0
  s_waitcnt vmcnt(19)
  buffer_load_dwordx4 a[32:35], v1, s[36:39], s42 offen offset:0 nt
  v_mfma_f32_16x16x32_bf16 v[32:35], v[16:19], a[52:55], v[32:35]
  s_waitcnt vmcnt(19)
  buffer_load_dwordx4 a[36:39], v1, s[36:39], s42 offen offset:1024 nt
  v_mov_b32_dpp v5, v28 quad_perm:[0,0,0,0] row_mask:0xf bank_mask:0xf
  v_add_f32_dpp v5, v29, v5 quad_perm:[1,1,1,1] row_mask:0xf bank_mask:0xf
  v_mfma_f32_16x16x32_bf16 v[32:35], v[20:23], a[56:59], v[32:35]
  s_waitcnt vmcnt(19)
  buffer_load_dwordx4 a[40:43], v1, s[36:39], s42 offen offset:2048 nt
  v_add_f32_dpp v5, v30, v5 quad_perm:[2,2,2,2] row_mask:0xf bank_mask:0xf
  v_add_f32_dpp v5, v31, v5 quad_perm:[3,3,3,3] row_mask:0xf bank_mask:0xf
  v_mfma_f32_16x16x32_bf16 v[32:35], v[24:27], a[60:63], v[32:35]
  s_waitcnt vmcnt(19)
  buffer_load_dwordx4 a[44:47], v1, s[36:39], s42 offen offset:3072 nt
  v_max_f32 v6, v6, v5
  ds_write_b32 v3, v5 offset:192
  s_add_u32 s42, s42, s46
  v_mfma_f32_16x16x32_bf16 v[28:31], v[12:15], a[64:67], 0
  s_waitcnt vmcnt(19)
  buffer_load_dwordx4 a[48:51], v1, s[36:39], s42 offen offset:0 nt
  v_mfma_f32_16x16x32_bf16 v[28:31], v[16:19], a[68:71], v[28:31]
  s_waitcnt vmcnt(19)
  buffer_load_dwordx4 a[52:55], v1, s[36:39], s42 offen offset:1024 nt
  v_mov_b32_dpp v5, v32 quad_perm:[0,0,0,0] row_mask:0xf bank_mask:0xf
  v_add_f32_dpp v5, v33, v5 quad_perm:[1,1,1,1] row_mask:0xf bank_mask:0xf
  v_mfma_f32_16x16x32_bf16 v[28:31], v[20:23], a[72:75], v[28:31]
  s_waitcnt vmcnt(19)
  buffer_load_dwordx4 a[56:59], v1, s[36:39], s42 offen offset:2048 nt
  v_add_f32_dpp v5, v34, v5 quad_perm:[2,2,2,2] row_mask:0xf bank_mask:0xf
  v_add_f32_dpp v5, v35, v5 quad_perm:[3,3,3,3] row_mask:0xf bank_mask:0xf
  v_mfma_f32_16x16x32_bf16 v[28:31], v[24:27], a[76:79], v[28:31]
  s_waitcnt vmcnt(19)
  buffer_load_dwordx4 a[60:63], v1, s[36:39], s42 offen offset:3072 nt
  v_max_f32 v6, v6, v5
  ds_write_b32 v3, v5 offset:256
  s_add_u32 s42, s42, s46
  v_mfma_f32_16x16x32_bf16 v[32:35], v[12:15], a[80:83], 0
  s_waitcnt vmcnt(19)
  buffer_load_dwordx4 a[64:67], v1, s[36:39], s42 offen offset:0 nt
  v_mfma_f32_16x16x32_bf16 v[32:35], v[16:19], a[84:87], v[32:35]
  s_waitcnt vmcnt(19)
  buffer_load_dwordx4 a[68:71], v1, s[36:39], s42 offen offset:1024 nt
  v_mov_b32_dpp v5, v28 quad_perm:[0,0,0,0] row_mask:0xf bank_mask:0xf
  v_add_f32_dpp v5, v29, v5 quad_perm:[1,1,1,1] row_mask:0xf bank_mask:0xf
  v_mfma_f32_16x16x32_bf16 v[32:35], v[20:23], a[88:91], v[32:35]
  s_waitcnt vmcnt(19)
  buffer_load_dwordx4 a[72:75], v1, s[36:39], s42 offen offset:2048 nt
  v_add_f32_dpp v5, v30, v5 quad_perm:[2,2,2,2] row_mask:0xf bank_mask:0xf
  v_add_f32_dpp v5, v31, v5 quad_perm:[3,3,3,3] row_mask:0xf bank_mask:0xf
  v_mfma_f32_16x16x32_bf16 v[32:35], v[24:27], a[92:95], v[32:35]
  s_waitcnt vmcnt(19)
  buffer_load_dwordx4 a[76:79], v1, s[36:39], s42 offen offset:3072 nt
  v_max_f32 v6, v6, v5
  ds_write_b32 v3, v5 offset:320
  s_add_u32 s42, s42, s46
  v_mfma_f32_16x16x32_bf16 v[28:31], v[12:15], a[96:99], 0
  s_waitcnt vmcnt(19)
  buffer_load_dwordx4 a[80:83], v1, s[36:39], s42 offen offset:0 nt
  v_mfma_f32_16x16x32_bf16 v[28:31], v[16:19], a[100:103], v[28:31]
  s_waitcnt vmcnt(19)
  buffer_load_dwordx4 a[84:87], v1, s[36:39], s42 offen offset:1024 nt
  v_mov_b32_dpp v5, v32 quad_perm:[0,0,0,0] row_mask:0xf bank_mask:0xf
  v_add_f32_dpp v5, v33, v5 quad_perm:[1,1,1,1] row_mask:0xf bank_mask:0xf
  v_mfma_f32_16x16x32_bf16 v[28:31], v[20:23], a[104:107], v[28:31]
  s_waitcnt vmcnt(19)
  buffer_load_dwordx4 a[88:91], v1, s[36:39], s42 offen offset:2048 nt
  v_add_f32_dpp v5, v34, v5 quad_perm:[2,2,2,2] row_mask:0xf bank_mask:0xf
  v_add_f32_dpp v5, v35, v5 quad_perm:[3,3,3,3] row_mask:0xf bank_mask:0xf
  v_mfma_f32_16x16x32_bf16 v[28:31], v[24:27], a[108:111], v[28:31]
  s_waitcnt vmcnt(19)
  buffer_load_dwordx4 a[92:95], v1, s[36:39], s42 offen offset:3072 nt
  v_max_f32 v6, v6, v5
  ds_write_b32 v3, v5 offset:384
  s_add_u32 s42, s42, s46
  v_mfma_f32_16x16x32_bf16 v[32:35], v[12:15], a[112:115], 0
  s_waitcnt vmcnt(19)
  buffer_load_dwordx4 a[96:99], v1, s[36:39], s42 offen offset:0 nt
  v_mfma_f32_16x16x32_bf16 v[32:35], v[16:19], a[116:119], v[32:35]
  s_waitcnt vmcnt(19)
  buffer_load_dwordx4 a[100:103], v1, s[36:39], s42 offen offset:1024 nt
  v_mov_b32_dpp v5, v28 quad_perm:[0,0,0,0] row_mask:0xf bank_mask:0xf
  v_add_f32_dpp v5, v29, v5 quad_perm:[1,1,1,1] row_mask:0xf bank_mask:0xf
  v_mfma_f32_16x16x32_bf16 v[32:35], v[20:23], a[120:123], v[32:35]
  s_waitcnt vmcnt(19)
  buffer_load_dwordx4 a[104:107], v1, s[36:39], s42 offen offset:2048 nt
  v_add_f32_dpp v5, v30, v5 quad_perm:[2,2,2,2] row_mask:0xf bank_mask:0xf
  v_add_f32_dpp v5, v31, v5 quad_perm:[3,3,3,3] row_mask:0xf bank_mask:0xf
  v_mfma_f32_16x16x32_bf16 v[32:35], v[24:27], a[124:127], v[32:35]
  s_waitcnt vmcnt(19)
  buffer_load_dwordx4 a[108:111], v1, s[36:39], s42 offen offset:3072 nt
  v_max_f32 v6, v6, v5
  ds_write_b32 v3, v5 offset:448
  s_add_u32 s42, s42, s46
  v_mfma_f32_16x16x32_bf16 v[28:31], v[12:15], a[128:131], 0
  s_waitcnt vmcnt(19)
  buffer_load_dwordx4 a[112:115], v1, s[36:39], s42 offen offset:0 nt
  v_mfma_f32_16x16x32_bf16 v[28:31], v[16:19], a[132:135], v[28:31]
  s_waitcnt vmcnt(19)
  buffer_load_dwordx4 a[116:119], v1, s[36:39], s42 offen offset:1024 nt
  v_mov_b32_dpp v5, v32 quad_perm:[0,0,0,0] row_mask:0xf bank_mask:0xf
  v_add_f32_dpp v5, v33, v5 quad_perm:[1,1,1,1] row_mask:0xf bank_mask:0xf
  v_mfma_f32_16x16x32_bf16 v[28:31], v[20:23], a[136:139], v[28:31]
  s_waitcnt vmcnt(19)
  buffer_load_dwordx4 a[120:123], v1, s[36:39], s42 offen offset:2048 nt
  v_add_f32_dpp v5, v34, v5 quad_perm:[2,2,2,2] row_mask:0xf bank_mask:0xf
  v_add_f32_dpp v5, v35, v5 quad_perm:[3,3,3,3] row_mask:0xf bank_mask:0xf
  v_mfma_f32_16x16x32_bf16 v[28:31], v[24:27], a[140:143], v[28:31]
  s_waitcnt vmcnt(19)
  buffer_load_dwordx4 a[124:127], v1, s[36:39], s42 offen offset:3072 nt
  v_max_f32 v6, v6, v5
  ds_write_b32 v3, v5 offset:512
  s_add_u32 s42, s42, s46
  s_and_b32 s47, s42, 0x10000
  s_mul_i32 s47, s47, 3
  s_add_u32 s42, s42, s47
  s_and_b32 s42, s42, 0x1fffff
  v_mfma_f32_16x16x32_bf16 v[32:35], v[12:15], a[144:147], 0
  s_waitcnt vmcnt(19)
  buffer_load_dwordx4 a[128:131], v1, s[36:39], s42 offen offset:0 nt
  v_mfma_f32_16x16x32_bf16 v[32:35], v[16:19], a[148:151], v[32:35]
  s_waitcnt vmcnt(19)
  buffer_load_dwordx4 a[132:135], v1, s[36:39], s42 offen offset:1024 nt
  v_mov_b32_dpp v5, v28 quad_perm:[0,0,0,0] row_mask:0xf bank_mask:0xf
  v_add_f32_dpp v5, v29, v5 quad_perm:[1,1,1,1] row_mask:0xf bank_mask:0xf
  v_mfma_f32_16x16x32_bf16 v[32:35], v[20:23], a[152:155], v[32:35]
  s_waitcnt vmcnt(19)
  buffer_load_dwordx4 a[136:139], v1, s[36:39], s42 offen offset:2048 nt
  v_add_f32_dpp v5, v30, v5 quad_perm:[2,2,2,2] row_mask:0xf bank_mask:0xf
  v_add_f32_dpp v5, v31, v5 quad_perm:[3,3,3,3] row_mask:0xf bank_mask:0xf
  v_mfma_f32_16x16x32_bf16 v[32:35], v[24:27], a[156:159], v[32:35]
  s_waitcnt vmcnt(19)
  buffer_load_dwordx4 a[140:143], v1, s[36:39], s42 offen offset:3072 nt
  v_max_f32 v6, v6, v5
  ds_write_b32 v3, v5 offset:576
  s_add_u32 s42, s42, s46
  v_mfma_f32_16x16x32_bf16 v[28:31], v[12:15], a[160:163], 0
  s_waitcnt vmcnt(19)
  buffer_load_dwordx4 a[144:147], v1, s[36:39], s42 offen offset:0 nt
  v_mfma_f32_16x16x32_bf16 v[28:31], v[16:19], a[164:167], v[28:31]
  s_waitcnt vmcnt(19)
  buffer_load_dwordx4 a[148:151], v1, s[36:39], s42 offen offset:1024 nt
  v_mov_b32_dpp v5, v32 quad_perm:[0,0,0,0] row_mask:0xf bank_mask:0xf
  v_add_f32_dpp v5, v33, v5 quad_perm:[1,1,1,1] row_mask:0xf bank_mask:0xf
  v_mfma_f32_16x16x32_bf16 v[28:31], v[20:23], a[168:171], v[28:31]
  s_waitcnt vmcnt(19)
  buffer_load_dwordx4 a[152:155], v1, s[36:39], s42 offen offset:2048 nt
  v_add_f32_dpp v5, v34, v5 quad_perm:[2,2,2,2] row_mask:0xf bank_mask:0xf
  v_add_f32_dpp v5, v35, v5 quad_perm:[3,3,3,3] row_mask:0xf bank_mask:0xf
  v_mfma_f32_16x16x32_bf16 v[28:31], v[24:27], a[172:175], v[28:31]
  s_waitcnt vmcnt(19)
  buffer_load_dwordx4 a[156:159], v1, s[36:39], s42 offen offset:3072 nt
  v_max_f32 v6, v6, v5
  ds_write_b32 v3, v5 offset:640
  s_add_u32 s42, s42, s46
  v_mfma_f32_16x16x32_bf16 v[32:35], v[12:15], a[176:179], 0
  s_waitcnt vmcnt(19)
  buffer_load_dwordx4 a[160:163], v1, s[36:39], s42 offen offset:0 nt
  v_mfma_f32_16x16x32_bf16 v[32:35], v[16:19], a[180:183], v[32:35]
  s_waitcnt vmcnt(19)
  buffer_load_dwordx4 a[164:167], v1, s[36:39], s42 offen offset:1024 nt
  v_mov_b32_dpp v5, v28 quad_perm:[0,0,0,0] row_mask:0xf bank_mask:0xf
  v_add_f32_dpp v5, v29, v5 quad_perm:[1,1,1,1] row_mask:0xf bank_mask:0xf
  v_mfma_f32_16x16x32_bf16 v[32:35], v[20:23], a[184:187], v[32:35]
  s_waitcnt vmcnt(19)
  buffer_load_dwordx4 a[168:171], v1, s[36:39], s42 offen offset:2048 nt
  v_add_f32_dpp v5, v30, v5 quad_perm:[2,2,2,2] row_mask:0xf bank_mask:0xf
  v_add_f32_dpp v5, v31, v5 quad_perm:[3,3,3,3] row_mask:0xf bank_mask:0xf
  v_mfma_f32_16x16x32_bf16 v[32:35], v[24:27], a[188:191], v[32:35]
  s_waitcnt vmcnt(19)
  buffer_load_dwordx4 a[172:175], v1, s[36:39], s42 offen offset:3072 nt
  v_max_f32 v6, v6, v5
  ds_write_b32 v3, v5 offset:704
  s_add_u32 s42, s42, s46
  v_mfma_f32_16x16x32_bf16 v[28:31], v[12:15], a[192:195], 0
  s_waitcnt vmcnt(19)
  buffer_load_dwordx4 a[176:179], v1, s[36:39], s42 offen offset:0 nt
  v_mfma_f32_16x16x32_bf16 v[28:31], v[16:19], a[196:199], v[28:31]
  s_waitcnt vmcnt(19)
  buffer_load_dwordx4 a[180:183], v1, s[36:39], s42 offen offset:1024 nt
  v_mov_b32_dpp v5, v32 quad_perm:[0,0,0,0] row_mask:0xf bank_mask:0xf
  v_add_f32_dpp v5, v33, v5 quad_perm:[1,1,1,1] row_mask:0xf bank_mask:0xf
  v_mfma_f32_16x16x32_bf16 v[28:31], v[20:23], a[200:203], v[28:31]
  s_waitcnt vmcnt(19)
  buffer_load_dwordx4 a[184:187], v1, s[36:39], s42 offen offset:2048 nt
  v_add_f32_dpp v5, v34, v5 quad_perm:[2,2,2,2] row_mask:0xf bank_mask:0xf
  v_add_f32_dpp v5, v35, v5 quad_perm:[3,3,3,3] row_mask:0xf bank_mask:0xf
  v_mfma_f32_16x16x32_bf16 v[28:31], v[24:27], a[204:207], v[28:31]
  s_waitcnt vmcnt(19)
  buffer_load_dwordx4 a[188:191], v1, s[36:39], s42 offen offset:3072 nt
  v_max_f32 v6, v6, v5
  ds_write_b32 v3, v5 offset:768
  s_add_u32 s42, s42, s46
  v_mfma_f32_16x16x32_bf16 v[32:35], v[12:15], a[208:211], 0
  s_waitcnt vmcnt(19)
  buffer_load_dwordx4 a[192:195], v1, s[36:39], s42 offen offset:0 nt
  v_mfma_f32_16x16x32_bf16 v[32:35], v[16:19], a[212:215], v[32:35]
  s_waitcnt vmcnt(19)
  buffer_load_dwordx4 a[196:199], v1, s[36:39], s42 offen offset:1024 nt
  v_mov_b32_dpp v5, v28 quad_perm:[0,0,0,0] row_mask:0xf bank_mask:0xf
  v_add_f32_dpp v5, v29, v5 quad_perm:[1,1,1,1] row_mask:0xf bank_mask:0xf
  v_mfma_f32_16x16x32_bf16 v[32:35], v[20:23], a[216:219], v[32:35]
  s_waitcnt vmcnt(19)
  buffer_load_dwordx4 a[200:203], v1, s[36:39], s42 offen offset:2048 nt
  v_add_f32_dpp v5, v30, v5 quad_perm:[2,2,2,2] row_mask:0xf bank_mask:0xf
  v_add_f32_dpp v5, v31, v5 quad_perm:[3,3,3,3] row_mask:0xf bank_mask:0xf
  v_mfma_f32_16x16x32_bf16 v[32:35], v[24:27], a[220:223], v[32:35]
  s_waitcnt vmcnt(19)
  buffer_load_dwordx4 a[204:207], v1, s[36:39], s42 offen offset:3072 nt
  v_max_f32 v6, v6, v5
  ds_write_b32 v3, v5 offset:832
  s_add_u32 s42, s42, s46
  v_mfma_f32_16x16x32_bf16 v[28:31], v[12:15], a[224:227], 0
  s_waitcnt vmcnt(19)
  buffer_load_dwordx4 a[208:211], v1, s[36:39], s42 offen offset:0 nt
  v_mfma_f32_16x16x32_bf16 v[28:31], v[16:19], a[228:231], v[28:31]
  s_waitcnt vmcnt(19)
  buffer_load_dwordx4 a[212:215], v1, s[36:39], s42 offen offset:1024 nt
  v_mov_b32_dpp v5, v32 quad_perm:[0,0,0,0] row_mask:0xf bank_mask:0xf
  v_add_f32_dpp v5, v33, v5 quad_perm:[1,1,1,1] row_mask:0xf bank_mask:0xf
  v_mfma_f32_16x16x32_bf16 v[28:31], v[20:23], a[232:235], v[28:31]
  s_waitcnt vmcnt(19)
  buffer_load_dwordx4 a[216:219], v1, s[36:39], s42 offen offset:2048 nt
  v_add_f32_dpp v5, v34, v5 quad_perm:[2,2,2,2] row_mask:0xf bank_mask:0xf
  v_add_f32_dpp v5, v35, v5 quad_perm:[3,3,3,3] row_mask:0xf bank_mask:0xf
  v_mfma_f32_16x16x32_bf16 v[28:31], v[24:27], a[236:239], v[28:31]
  s_waitcnt vmcnt(19)
  buffer_load_dwordx4 a[220:223], v1, s[36:39], s42 offen offset:3072 nt
  v_max_f32 v6, v6, v5
  ds_write_b32 v3, v5 offset:896
  s_add_u32 s42, s42, s46
  v_mfma_f32_16x16x32_bf16 v[32:35], v[12:15], a[240:243], 0
  s_waitcnt vmcnt(19)
  buffer_load_dwordx4 a[224:227], v1, s[36:39], s42 offen offset:0 nt
  v_mfma_f32_16x16x32_bf16 v[32:35], v[16:19], a[244:247], v[32:35]
  s_waitcnt vmcnt(19)
  buffer_load_dwordx4 a[228:231], v1, s[36:39], s42 offen offset:1024 nt
  v_mov_b32_dpp v5, v28 quad_perm:[0,0,0,0] row_mask:0xf bank_mask:0xf
  v_add_f32_dpp v5, v29, v5 quad_perm:[1,1,1,1] row_mask:0xf bank_mask:0xf
  v_mfma_f32_16x16x32_bf16 v[32:35], v[20:23], a[248:251], v[32:35]
  s_waitcnt vmcnt(19)
  buffer_load_dwordx4 a[232:235], v1, s[36:39], s42 offen offset:2048 nt
  v_add_f32_dpp v5, v30, v5 quad_perm:[2,2,2,2] row_mask:0xf bank_mask:0xf
  v_add_f32_dpp v5, v31, v5 quad_perm:[3,3,3,3] row_mask:0xf bank_mask:0xf
  v_mfma_f32_16x16x32_bf16 v[32:35], v[24:27], a[252:255], v[32:35]
  s_waitcnt vmcnt(19)
  buffer_load_dwordx4 a[236:239], v1, s[36:39], s42 offen offset:3072 nt
  v_max_f32 v6, v6, v5
  ds_write_b32 v3, v5 offset:960
  s_add_u32 s42, s42, s46
  v_add_u32 v3, 1024, v3
  s_add_u32 s43, s43, 1
  s_cmp_lt_u32 s43, 8
  s_cbranch_scc1 L_kloop
  ds_read_b32 v36, v4
  v_mov_b32_dpp v5, v32 quad_perm:[0,0,0,0] row_mask:0xf bank_mask:0xf
  v_add_f32_dpp v5, v33, v5 quad_perm:[1,1,1,1] row_mask:0xf bank_mask:0xf
  v_add_f32_dpp v5, v34, v5 quad_perm:[2,2,2,2] row_mask:0xf bank_mask:0xf
  v_add_f32_dpp v5, v35, v5 quad_perm:[3,3,3,3] row_mask:0xf bank_mask:0xf
  v_max_f32 v6, v6, v5
  ds_write_b32 v3, v5
  v_mov_b32 v46, 1
  s_waitcnt vmcnt(19)
  buffer_load_dwordx4 a[240:243], v1, s[36:39], s42 offen offset:0 nt
  v_max_f32_dpp v6, v6, v6 row_ror:4 row_mask:0xf bank_mask:0xf
  ds_write_b32 v45, v46
  v_mov_b32 v20, 0
  v_max_f32_dpp v6, v6, v6 row_ror:8 row_mask:0xf bank_mask:0xf
  v_mov_b32 v21, 0
  v_mov_b32 v22, 0
  v_max_f32_dpp v6, v6, v6 row_bcast:15 row_mask:0xa bank_mask:0xf
  v_mov_b32 v23, 0
  v_mov_b32 v24, 0
  s_waitcnt vmcnt(19)
  buffer_load_dwordx4 a[244:247], v1, s[36:39], s42 offen offset:1024 nt
  v_max_f32_dpp v6, v6, v6 row_bcast:31 row_mask:0xc bank_mask:0xf
  v_mov_b32 v25, 0
  v_readlane_b32 s3, v6, 63
  v_mov_b32 v26, 0
  v_mov_b32 v7, s45
  v_mul_f32 v7, s3, v7
  v_mov_b32 v27, 0
  s_mov_b32 s43, 0
  s_waitcnt lgkmcnt(0)
  s_waitcnt vmcnt(19)
  buffer_load_dwordx4 a[248:251], v1, s[36:39], s42 offen offset:2048 nt
  v_fma_f32 v36, v36, s45, -v7
  v_exp_f32 v36, v36
  v_mov_b32 v12, 0
  v_mov_b32 v13, 0
  v_mov_b32 v14, 0
  v_mov_b32 v15, 0
  v_mov_b32 v16, 0
  v_mov_b32 v17, 0
  v_mov_b32 v18, 0
  s_waitcnt vmcnt(19)
  buffer_load_dwordx4 a[252:255], v1, s[36:39], s42 offen offset:3072 nt
  s_add_u32 s42, s42, s46
  s_and_b32 s47, s42, 0x10000
  s_mul_i32 s47, s47, 3
  s_add_u32 s42, s42, s47
  s_and_b32 s42, s42, 0x1fffff
  v_mov_b32 v19, 0
  v_and_b32 v41, 0xffff0000, v36
  v_sub_f32 v36, v36, v41
  v_cvt_pk_bf16_f32 v37, v36, v41
  s_mov_b64 vcc, 0
  s_nop 0
  v_mov_b32_dpp v38, v37 row_half_mirror row_mask:0xf bank_mask:0xf
  s_nop 1
  v_mov_b32_dpp v12, v37 quad_perm:[0,0,0,0] row_mask:0xf bank_mask:0x5
  v_mov_b32_dpp v13, v38 quad_perm:[3,3,3,3] row_mask:0xf bank_mask:0xa
  v_mov_b32_dpp v14, v38 quad_perm:[3,3,3,3] row_mask:0xf bank_mask:0x5
  v_mov_b32_dpp v15, v37 quad_perm:[0,0,0,0] row_mask:0xf bank_mask:0xa
  s_nop 1
.p2align 3
L_vloop:
  v_smfmac_f32_16x16x64_bf16 v[20:23], v[12:15], a[0:7], v8
  s_waitcnt vmcnt(27)
  s_cbranch_vccnz L_w1
  s_waitcnt vmcnt(17)
L_w1:
  buffer_load_dwordx4 a[0:3], v1, s[36:39], s42 offen offset:0 nt
  v_mov_b32_dpp v16, v37 quad_perm:[1,1,1,1] row_mask:0xf bank_mask:0x5
  v_mov_b32_dpp v17, v38 quad_perm:[2,2,2,2] row_mask:0xf bank_mask:0xa
  s_waitcnt vmcnt(27)
  s_cbranch_vccnz L_w2
  s_waitcnt vmcnt(17)
L_w2:
  buffer_load_dwordx4 a[4:7], v1, s[36:39], s42 offen offset:1024 nt
  v_mov_b32_dpp v18, v38 quad_perm:[2,2,2,2] row_mask:0xf bank_mask:0x5
  v_mov_b32_dpp v19, v37 quad_perm:[1,1,1,1] row_mask:0xf bank_mask:0xa
  v_smfmac_f32_16x16x64_bf16 v[24:27], v[12:15], a[8:15], v8
  s_waitcnt vmcnt(27)
  s_cbranch_vccnz L_w3
  s_waitcnt vmcnt(17)
L_w3:
  buffer_load_dwordx4 a[8:11], v1, s[36:39], s42 offen offset:2048 nt
  ds_read_b32 v36, v4 offset:256
  ds_read_b32 v42, v45 offset:4
  s_waitcnt vmcnt(27)
  s_cbranch_vccnz L_w4
  s_waitcnt vmcnt(17)
L_w4:
  buffer_load_dwordx4 a[12:15], v1, s[36:39], s42 offen offset:3072 nt
  s_add_u32 s42, s42, s46
  v_smfmac_f32_16x16x64_bf16 v[20:23], v[16:19], a[16:23], v8
  s_waitcnt vmcnt(27)
  s_cbranch_vccnz L_w5
  s_waitcnt vmcnt(17)
L_w5:
  buffer_load_dwordx4 a[16:19], v1, s[36:39], s42 offen offset:0 nt
  v_mov_b32_dpp v12, v37 quad_perm:[2,2,2,2] row_mask:0xf bank_mask:0x5
  v_mov_b32_dpp v13, v38 quad_perm:[1,1,1,1] row_mask:0xf bank_mask:0xa
  s_waitcnt vmcnt(27)
  s_cbranch_vccnz L_w6
  s_waitcnt vmcnt(17)
L_w6:
  buffer_load_dwordx4 a[20:23], v1, s[36:39], s42 offen offset:1024 nt
  v_mov_b32_dpp v14, v38 quad_perm:[1,1,1,1] row_mask:0xf bank_mask:0x5
  v_mov_b32_dpp v15, v37 quad_perm:[2,2,2,2] row_mask:0xf bank_mask:0xa
  v_smfmac_f32_16x16x64_bf16 v[24:27], v[16:19], a[24:31], v8
  s_waitcnt vmcnt(27)
  s_cbranch_vccnz L_w7
  s_waitcnt vmcnt(17)
L_w7:
  buffer_load_dwordx4 a[24:27], v1, s[36:39], s42 offen offset:2048 nt
  s_waitcnt lgkmcnt(0)
  v_fma_f32 v36, v36, s45, -v7
  v_exp_f32 v36, v36
  v_bfe_u32 v42, v42, v46, 1
  v_cmp_ne_u32 vcc, 0, v42
  s_waitcnt vmcnt(27)
  s_cbranch_vccnz L_w8
  s_waitcnt vmcnt(17)
L_w8:
  buffer_load_dwordx4 a[28:31], v1, s[36:39], s42 offen offset:3072 nt
  s_add_u32 s42, s42, s46
  v_smfmac_f32_16x16x64_bf16 v[20:23], v[12:15], a[32:39], v8
  s_waitcnt vmcnt(27)
  s_cbranch_vccnz L_w9
  s_waitcnt vmcnt(17)
L_w9:
  buffer_load_dwordx4 a[32:35], v1, s[36:39], s42 offen offset:0 nt
  v_mov_b32_dpp v16, v37 quad_perm:[3,3,3,3] row_mask:0xf bank_mask:0x5
  v_mov_b32_dpp v17, v38 quad_perm:[0,0,0,0] row_mask:0xf bank_mask:0xa
  v_and_b32 v41, 0xffff0000, v36
  v_sub_f32 v36, v36, v41
  s_waitcnt vmcnt(27)
  s_cbranch_vccnz L_w10
  s_waitcnt vmcnt(17)
L_w10:
  buffer_load_dwordx4 a[36:39], v1, s[36:39], s42 offen offset:1024 nt
  v_mov_b32_dpp v18, v38 quad_perm:[0,0,0,0] row_mask:0xf bank_mask:0x5
  v_mov_b32_dpp v19, v37 quad_perm:[3,3,3,3] row_mask:0xf bank_mask:0xa
  v_cvt_pk_bf16_f32 v39, v36, v41
  v_smfmac_f32_16x16x64_bf16 v[24:27], v[12:15], a[40:47], v8
  s_waitcnt vmcnt(27)
  s_cbranch_vccnz L_w11
  s_waitcnt vmcnt(17)
L_w11:
  buffer_load_dwordx4 a[40:43], v1, s[36:39], s42 offen offset:2048 nt
  s_waitcnt vmcnt(27)
  s_cbranch_vccnz L_w12
  s_waitcnt vmcnt(17)
L_w12:
  buffer_load_dwordx4 a[44:47], v1, s[36:39], s42 offen offset:3072 nt
  s_add_u32 s42, s42, s46
  v_mov_b32_dpp v40, v39 row_half_mirror row_mask:0xf bank_mask:0xf
  v_smfmac_f32_16x16x64_bf16 v[20:23], v[16:19], a[48:55], v8
  s_waitcnt vmcnt(27)
  s_cbranch_vccnz L_w13
  s_waitcnt vmcnt(17)
L_w13:
  buffer_load_dwordx4 a[48:51], v1, s[36:39], s42 offen offset:0 nt
  v_mov_b32_dpp v12, v39 quad_perm:[0,0,0,0] row_mask:0xf bank_mask:0x5
  v_mov_b32_dpp v13, v40 quad_perm:[3,3,3,3] row_mask:0xf bank_mask:0xa
  s_waitcnt vmcnt(27)
  s_cbranch_vccnz L_w14
  s_waitcnt vmcnt(17)
L_w14:
  buffer_load_dwordx4 a[52:55], v1, s[36:39], s42 offen offset:1024 nt
  v_mov_b32_dpp v14, v40 quad_perm:[3,3,3,3] row_mask:0xf bank_mask:0x5
  v_mov_b32_dpp v15, v39 quad_perm:[0,0,0,0] row_mask:0xf bank_mask:0xa
  v_smfmac_f32_16x16x64_bf16 v[24:27], v[16:19], a[56:63], v8
  s_waitcnt vmcnt(27)
  s_cbranch_vccnz L_w15
  s_waitcnt vmcnt(17)
L_w15:
  buffer_load_dwordx4 a[56:59], v1, s[36:39], s42 offen offset:2048 nt
  s_waitcnt vmcnt(27)
  s_cbranch_vccnz L_w16
  s_waitcnt vmcnt(17)
L_w16:
  buffer_load_dwordx4 a[60:63], v1, s[36:39], s42 offen offset:3072 nt
  s_add_u32 s42, s42, s46
  v_add_u32 v46, 1, v46
  ds_write_b32 v45, v46
  v_smfmac_f32_16x16x64_bf16 v[20:23], v[12:15], a[64:71], v8
  s_waitcnt vmcnt(27)
  s_cbranch_vccnz L_w17
  s_waitcnt vmcnt(17)
L_w17:
  buffer_load_dwordx4 a[64:67], v1, s[36:39], s42 offen offset:0 nt
  v_mov_b32_dpp v16, v39 quad_perm:[1,1,1,1] row_mask:0xf bank_mask:0x5
  v_mov_b32_dpp v17, v40 quad_perm:[2,2,2,2] row_mask:0xf bank_mask:0xa
  s_waitcnt vmcnt(27)
  s_cbranch_vccnz L_w18
  s_waitcnt vmcnt(17)
L_w18:
  buffer_load_dwordx4 a[68:71], v1, s[36:39], s42 offen offset:1024 nt
  v_mov_b32_dpp v18, v40 quad_perm:[2,2,2,2] row_mask:0xf bank_mask:0x5
  v_mov_b32_dpp v19, v39 quad_perm:[1,1,1,1] row_mask:0xf bank_mask:0xa
  v_smfmac_f32_16x16x64_bf16 v[24:27], v[12:15], a[72:79], v8
  s_waitcnt vmcnt(27)
  s_cbranch_vccnz L_w19
  s_waitcnt vmcnt(17)
L_w19:
  buffer_load_dwordx4 a[72:75], v1, s[36:39], s42 offen offset:2048 nt
  ds_read_b32 v36, v4 offset:512
  ds_read_b32 v42, v45 offset:4
  s_waitcnt vmcnt(27)
  s_cbranch_vccnz L_w20
  s_waitcnt vmcnt(17)
L_w20:
  buffer_load_dwordx4 a[76:79], v1, s[36:39], s42 offen offset:3072 nt
  s_add_u32 s42, s42, s46
  v_smfmac_f32_16x16x64_bf16 v[20:23], v[16:19], a[80:87], v8
  s_waitcnt vmcnt(27)
  s_cbranch_vccnz L_w21
  s_waitcnt vmcnt(17)
L_w21:
  buffer_load_dwordx4 a[80:83], v1, s[36:39], s42 offen offset:0 nt
  v_mov_b32_dpp v12, v39 quad_perm:[2,2,2,2] row_mask:0xf bank_mask:0x5
  v_mov_b32_dpp v13, v40 quad_perm:[1,1,1,1] row_mask:0xf bank_mask:0xa
  s_waitcnt vmcnt(27)
  s_cbranch_vccnz L_w22
  s_waitcnt vmcnt(17)
L_w22:
  buffer_load_dwordx4 a[84:87], v1, s[36:39], s42 offen offset:1024 nt
  v_mov_b32_dpp v14, v40 quad_perm:[1,1,1,1] row_mask:0xf bank_mask:0x5
  v_mov_b32_dpp v15, v39 quad_perm:[2,2,2,2] row_mask:0xf bank_mask:0xa
  v_smfmac_f32_16x16x64_bf16 v[24:27], v[16:19], a[88:95], v8
  s_waitcnt vmcnt(27)
  s_cbranch_vccnz L_w23
  s_waitcnt vmcnt(17)
L_w23:
  buffer_load_dwordx4 a[88:91], v1, s[36:39], s42 offen offset:2048 nt
  s_waitcnt lgkmcnt(0)
  v_fma_f32 v36, v36, s45, -v7
  v_exp_f32 v36, v36
  v_bfe_u32 v42, v42, v46, 1
  v_cmp_ne_u32 vcc, 0, v42
  s_waitcnt vmcnt(27)
  s_cbranch_vccnz L_w24
  s_waitcnt vmcnt(17)
L_w24:
  buffer_load_dwordx4 a[92:95], v1, s[36:39], s42 offen offset:3072 nt
  s_add_u32 s42, s42, s46
  v_smfmac_f32_16x16x64_bf16 v[20:23], v[12:15], a[96:103], v8
  s_waitcnt vmcnt(27)
  s_cbranch_vccnz L_w25
  s_waitcnt vmcnt(17)
L_w25:
  buffer_load_dwordx4 a[96:99], v1, s[36:39], s42 offen offset:0 nt
  v_mov_b32_dpp v16, v39 quad_perm:[3,3,3,3] row_mask:0xf bank_mask:0x5
  v_mov_b32_dpp v17, v40 quad_perm:[0,0,0,0] row_mask:0xf bank_mask:0xa
  v_and_b32 v41, 0xffff0000, v36
  v_sub_f32 v36, v36, v41
  s_waitcnt vmcnt(27)
  s_cbranch_vccnz L_w26
  s_waitcnt vmcnt(17)
L_w26:
  buffer_load_dwordx4 a[100:103], v1, s[36:39], s42 offen offset:1024 nt
  v_mov_b32_dpp v18, v40 quad_perm:[0,0,0,0] row_mask:0xf bank_mask:0x5
  v_mov_b32_dpp v19, v39 quad_perm:[3,3,3,3] row_mask:0xf bank_mask:0xa
  v_cvt_pk_bf16_f32 v37, v36, v41
  v_smfmac_f32_16x16x64_bf16 v[24:27], v[12:15], a[104:111], v8
  s_waitcnt vmcnt(27)
  s_cbranch_vccnz L_w27
  s_waitcnt vmcnt(17)
L_w27:
  buffer_load_dwordx4 a[104:107], v1, s[36:39], s42 offen offset:2048 nt
  s_waitcnt vmcnt(27)
  s_cbranch_vccnz L_w28
  s_waitcnt vmcnt(17)
L_w28:
  buffer_load_dwordx4 a[108:111], v1, s[36:39], s42 offen offset:3072 nt
  s_add_u32 s42, s42, s46
  v_mov_b32_dpp v38, v37 row_half_mirror row_mask:0xf bank_mask:0xf
  v_smfmac_f32_16x16x64_bf16 v[20:23], v[16:19], a[112:119], v8
  s_waitcnt vmcnt(27)
  s_cbranch_vccnz L_w29
  s_waitcnt vmcnt(17)
L_w29:
  buffer_load_dwordx4 a[112:115], v1, s[36:39], s42 offen offset:0 nt
  v_mov_b32_dpp v12, v37 quad_perm:[0,0,0,0] row_mask:0xf bank_mask:0x5
  v_mov_b32_dpp v13, v38 quad_perm:[3,3,3,3] row_mask:0xf bank_mask:0xa
  s_waitcnt vmcnt(27)
  s_cbranch_vccnz L_w30
  s_waitcnt vmcnt(17)
L_w30:
  buffer_load_dwordx4 a[116:119], v1, s[36:39], s42 offen offset:1024 nt
  v_mov_b32_dpp v14, v38 quad_perm:[3,3,3,3] row_mask:0xf bank_mask:0x5
  v_mov_b32_dpp v15, v37 quad_perm:[0,0,0,0] row_mask:0xf bank_mask:0xa
  v_smfmac_f32_16x16x64_bf16 v[24:27], v[16:19], a[120:127], v8
  s_waitcnt vmcnt(27)
  s_cbranch_vccnz L_w31
  s_waitcnt vmcnt(17)
L_w31:
  buffer_load_dwordx4 a[120:123], v1, s[36:39], s42 offen offset:2048 nt
  s_waitcnt vmcnt(27)
  s_cbranch_vccnz L_w32
  s_waitcnt vmcnt(17)
L_w32:
  buffer_load_dwordx4 a[124:127], v1, s[36:39], s42 offen offset:3072 nt
  s_add_u32 s42, s42, s46
  s_and_b32 s47, s42, 0x10000
  s_mul_i32 s47, s47, 3
  s_add_u32 s42, s42, s47
  s_and_b32 s42, s42, 0x1fffff
  v_add_u32 v46, 1, v46
  ds_write_b32 v45, v46
  v_smfmac_f32_16x16x64_bf16 v[20:23], v[12:15], a[128:135], v8
  s_waitcnt vmcnt(27)
  s_cbranch_vccnz L_w33
  s_waitcnt vmcnt(17)
L_w33:
  buffer_load_dwordx4 a[128:131], v1, s[36:39], s42 offen offset:0 nt
  v_mov_b32_dpp v16, v37 quad_perm:[1,1,1,1] row_mask:0xf bank_mask:0x5
  v_mov_b32_dpp v17, v38 quad_perm:[2,2,2,2] row_mask:0xf bank_mask:0xa
  s_waitcnt vmcnt(27)
  s_cbranch_vccnz L_w34
  s_waitcnt vmcnt(17)
L_w34:
  buffer_load_dwordx4 a[132:135], v1, s[36:39], s42 offen offset:1024 nt
  v_mov_b32_dpp v18, v38 quad_perm:[2,2,2,2] row_mask:0xf bank_mask:0x5
  v_mov_b32_dpp v19, v37 quad_perm:[1,1,1,1] row_mask:0xf bank_mask:0xa
  v_smfmac_f32_16x16x64_bf16 v[24:27], v[12:15], a[136:143], v8
  s_waitcnt vmcnt(27)
  s_cbranch_vccnz L_w35
  s_waitcnt vmcnt(17)
L_w35:
  buffer_load_dwordx4 a[136:139], v1, s[36:39], s42 offen offset:2048 nt
  ds_read_b32 v36, v4 offset:768
  ds_read_b32 v42, v45 offset:4
  s_waitcnt vmcnt(27)
  s_cbranch_vccnz L_w36
  s_waitcnt vmcnt(17)
L_w36:
  buffer_load_dwordx4 a[140:143], v1, s[36:39], s42 offen offset:3072 nt
  s_add_u32 s42, s42, s46
  v_smfmac_f32_16x16x64_bf16 v[20:23], v[16:19], a[144:151], v8
  s_waitcnt vmcnt(27)
  s_cbranch_vccnz L_w37
  s_waitcnt vmcnt(17)
L_w37:
  buffer_load_dwordx4 a[144:147], v1, s[36:39], s42 offen offset:0 nt
  v_mov_b32_dpp v12, v37 quad_perm:[2,2,2,2] row_mask:0xf bank_mask:0x5
  v_mov_b32_dpp v13, v38 quad_perm:[1,1,1,1] row_mask:0xf bank_mask:0xa
  s_waitcnt vmcnt(27)
  s_cbranch_vccnz L_w38
  s_waitcnt vmcnt(17)
L_w38:
  buffer_load_dwordx4 a[148:151], v1, s[36:39], s42 offen offset:1024 nt
  v_mov_b32_dpp v14, v38 quad_perm:[1,1,1,1] row_mask:0xf bank_mask:0x5
  v_mov_b32_dpp v15, v37 quad_perm:[2,2,2,2] row_mask:0xf bank_mask:0xa
  v_smfmac_f32_16x16x64_bf16 v[24:27], v[16:19], a[152:159], v8
  s_waitcnt vmcnt(27)
  s_cbranch_vccnz L_w39
  s_waitcnt vmcnt(17)
L_w39:
  buffer_load_dwordx4 a[152:155], v1, s[36:39], s42 offen offset:2048 nt
  s_waitcnt lgkmcnt(0)
  v_fma_f32 v36, v36, s45, -v7
  v_exp_f32 v36, v36
  v_bfe_u32 v42, v42, v46, 1
  v_cmp_ne_u32 vcc, 0, v42
  s_waitcnt vmcnt(27)
  s_cbranch_vccnz L_w40
  s_waitcnt vmcnt(17)
L_w40:
  buffer_load_dwordx4 a[156:159], v1, s[36:39], s42 offen offset:3072 nt
  s_add_u32 s42, s42, s46
  v_smfmac_f32_16x16x64_bf16 v[20:23], v[12:15], a[160:167], v8
  s_waitcnt vmcnt(27)
  s_cbranch_vccnz L_w41
  s_waitcnt vmcnt(17)
L_w41:
  buffer_load_dwordx4 a[160:163], v1, s[36:39], s42 offen offset:0 nt
  v_mov_b32_dpp v16, v37 quad_perm:[3,3,3,3] row_mask:0xf bank_mask:0x5
  v_mov_b32_dpp v17, v38 quad_perm:[0,0,0,0] row_mask:0xf bank_mask:0xa
  v_and_b32 v41, 0xffff0000, v36
  v_sub_f32 v36, v36, v41
  s_waitcnt vmcnt(27)
  s_cbranch_vccnz L_w42
  s_waitcnt vmcnt(17)
L_w42:
  buffer_load_dwordx4 a[164:167], v1, s[36:39], s42 offen offset:1024 nt
  v_mov_b32_dpp v18, v38 quad_perm:[0,0,0,0] row_mask:0xf bank_mask:0x5
  v_mov_b32_dpp v19, v37 quad_perm:[3,3,3,3] row_mask:0xf bank_mask:0xa
  v_cvt_pk_bf16_f32 v39, v36, v41
  v_smfmac_f32_16x16x64_bf16 v[24:27], v[12:15], a[168:175], v8
  s_waitcnt vmcnt(27)
  s_cbranch_vccnz L_w43
  s_waitcnt vmcnt(17)
L_w43:
  buffer_load_dwordx4 a[168:171], v1, s[36:39], s42 offen offset:2048 nt
  s_waitcnt vmcnt(27)
  s_cbranch_vccnz L_w44
  s_waitcnt vmcnt(17)
L_w44:
  buffer_load_dwordx4 a[172:175], v1, s[36:39], s42 offen offset:3072 nt
  s_add_u32 s42, s42, s46
  v_mov_b32_dpp v40, v39 row_half_mirror row_mask:0xf bank_mask:0xf
  v_smfmac_f32_16x16x64_bf16 v[20:23], v[16:19], a[176:183], v8
  s_waitcnt vmcnt(27)
  s_cbranch_vccnz L_w45
  s_waitcnt vmcnt(17)
L_w45:
  buffer_load_dwordx4 a[176:179], v1, s[36:39], s42 offen offset:0 nt
  v_mov_b32_dpp v12, v39 quad_perm:[0,0,0,0] row_mask:0xf bank_mask:0x5
  v_mov_b32_dpp v13, v40 quad_perm:[3,3,3,3] row_mask:0xf bank_mask:0xa
  s_waitcnt vmcnt(27)
  s_cbranch_vccnz L_w46
  s_waitcnt vmcnt(17)
L_w46:
  buffer_load_dwordx4 a[180:183], v1, s[36:39], s42 offen offset:1024 nt
  v_mov_b32_dpp v14, v40 quad_perm:[3,3,3,3] row_mask:0xf bank_mask:0x5
  v_mov_b32_dpp v15, v39 quad_perm:[0,0,0,0] row_mask:0xf bank_mask:0xa
  v_smfmac_f32_16x16x64_bf16 v[24:27], v[16:19], a[184:191], v8
  s_waitcnt vmcnt(27)
  s_cbranch_vccnz L_w47
  s_waitcnt vmcnt(17)
L_w47:
  buffer_load_dwordx4 a[184:187], v1, s[36:39], s42 offen offset:2048 nt
  s_waitcnt vmcnt(27)
  s_cbranch_vccnz L_w48
  s_waitcnt vmcnt(17)
L_w48:
  buffer_load_dwordx4 a[188:191], v1, s[36:39], s42 offen offset:3072 nt
  s_add_u32 s42, s42, s46
  v_add_u32 v46, 1, v46
  ds_write_b32 v45, v46
  v_smfmac_f32_16x16x64_bf16 v[20:23], v[12:15], a[192:199], v8
  s_waitcnt vmcnt(27)
  s_cbranch_vccnz L_w49
  s_waitcnt vmcnt(17)
L_w49:
  buffer_load_dwordx4 a[192:195], v1, s[36:39], s42 offen offset:0 nt
  v_mov_b32_dpp v16, v39 quad_perm:[1,1,1,1] row_mask:0xf bank_mask:0x5
  v_mov_b32_dpp v17, v40 quad_perm:[2,2,2,2] row_mask:0xf bank_mask:0xa
  s_waitcnt vmcnt(27)
  s_cbranch_vccnz L_w50
  s_waitcnt vmcnt(17)
L_w50:
  buffer_load_dwordx4 a[196:199], v1, s[36:39], s42 offen offset:1024 nt
  v_mov_b32_dpp v18, v40 quad_perm:[2,2,2,2] row_mask:0xf bank_mask:0x5
  v_mov_b32_dpp v19, v39 quad_perm:[1,1,1,1] row_mask:0xf bank_mask:0xa
  v_smfmac_f32_16x16x64_bf16 v[24:27], v[12:15], a[200:207], v8
  s_waitcnt vmcnt(27)
  s_cbranch_vccnz L_w51
  s_waitcnt vmcnt(17)
L_w51:
  buffer_load_dwordx4 a[200:203], v1, s[36:39], s42 offen offset:2048 nt
  ds_read_b32 v36, v4 offset:1024
  ds_read_b32 v42, v45 offset:4
  s_waitcnt vmcnt(27)
  s_cbranch_vccnz L_w52
  s_waitcnt vmcnt(17)
L_w52:
  buffer_load_dwordx4 a[204:207], v1, s[36:39], s42 offen offset:3072 nt
  s_add_u32 s42, s42, s46
  v_smfmac_f32_16x16x64_bf16 v[20:23], v[16:19], a[208:215], v8
  s_waitcnt vmcnt(27)
  s_cbranch_vccnz L_w53
  s_waitcnt vmcnt(17)
L_w53:
  buffer_load_dwordx4 a[208:211], v1, s[36:39], s42 offen offset:0 nt
  v_mov_b32_dpp v12, v39 quad_perm:[2,2,2,2] row_mask:0xf bank_mask:0x5
  v_mov_b32_dpp v13, v40 quad_perm:[1,1,1,1] row_mask:0xf bank_mask:0xa
  s_waitcnt vmcnt(27)
  s_cbranch_vccnz L_w54
  s_waitcnt vmcnt(17)
L_w54:
  buffer_load_dwordx4 a[212:215], v1, s[36:39], s42 offen offset:1024 nt
  v_mov_b32_dpp v14, v40 quad_perm:[1,1,1,1] row_mask:0xf bank_mask:0x5
  v_mov_b32_dpp v15, v39 quad_perm:[2,2,2,2] row_mask:0xf bank_mask:0xa
  v_smfmac_f32_16x16x64_bf16 v[24:27], v[16:19], a[216:223], v8
  s_waitcnt vmcnt(27)
  s_cbranch_vccnz L_w55
  s_waitcnt vmcnt(17)
L_w55:
  buffer_load_dwordx4 a[216:219], v1, s[36:39], s42 offen offset:2048 nt
  s_waitcnt lgkmcnt(0)
  v_fma_f32 v36, v36, s45, -v7
  v_exp_f32 v36, v36
  v_bfe_u32 v42, v42, v46, 1
  v_cmp_ne_u32 vcc, 0, v42
  s_waitcnt vmcnt(27)
  s_cbranch_vccnz L_w56
  s_waitcnt vmcnt(17)
L_w56:
  buffer_load_dwordx4 a[220:223], v1, s[36:39], s42 offen offset:3072 nt
  s_add_u32 s42, s42, s46
  v_smfmac_f32_16x16x64_bf16 v[20:23], v[12:15], a[224:231], v8
  s_waitcnt vmcnt(27)
  s_cbranch_vccnz L_w57
  s_waitcnt vmcnt(17)
L_w57:
  buffer_load_dwordx4 a[224:227], v1, s[36:39], s42 offen offset:0 nt
  v_mov_b32_dpp v16, v39 quad_perm:[3,3,3,3] row_mask:0xf bank_mask:0x5
  v_mov_b32_dpp v17, v40 quad_perm:[0,0,0,0] row_mask:0xf bank_mask:0xa
  v_and_b32 v41, 0xffff0000, v36
  v_sub_f32 v36, v36, v41
  s_waitcnt vmcnt(27)
  s_cbranch_vccnz L_w58
  s_waitcnt vmcnt(17)
L_w58:
  buffer_load_dwordx4 a[228:231], v1, s[36:39], s42 offen offset:1024 nt
  v_mov_b32_dpp v18, v40 quad_perm:[0,0,0,0] row_mask:0xf bank_mask:0x5
  v_mov_b32_dpp v19, v39 quad_perm:[3,3,3,3] row_mask:0xf bank_mask:0xa
  v_cvt_pk_bf16_f32 v37, v36, v41
  v_smfmac_f32_16x16x64_bf16 v[24:27], v[12:15], a[232:239], v8
  s_waitcnt vmcnt(27)
  s_cbranch_vccnz L_w59
  s_waitcnt vmcnt(17)
L_w59:
  buffer_load_dwordx4 a[232:235], v1, s[36:39], s42 offen offset:2048 nt
  s_waitcnt vmcnt(27)
  s_cbranch_vccnz L_w60
  s_waitcnt vmcnt(17)
L_w60:
  buffer_load_dwordx4 a[236:239], v1, s[36:39], s42 offen offset:3072 nt
  s_add_u32 s42, s42, s46
  v_mov_b32_dpp v38, v37 row_half_mirror row_mask:0xf bank_mask:0xf
  v_smfmac_f32_16x16x64_bf16 v[20:23], v[16:19], a[240:247], v8
  s_waitcnt vmcnt(27)
  s_cbranch_vccnz L_w61
  s_waitcnt vmcnt(17)
L_w61:
  buffer_load_dwordx4 a[240:243], v1, s[36:39], s42 offen offset:0 nt
  v_mov_b32_dpp v12, v37 quad_perm:[0,0,0,0] row_mask:0xf bank_mask:0x5
  v_mov_b32_dpp v13, v38 quad_perm:[3,3,3,3] row_mask:0xf bank_mask:0xa
  s_waitcnt vmcnt(27)
  s_cbranch_vccnz L_w62
  s_waitcnt vmcnt(17)
L_w62:
  buffer_load_dwordx4 a[244:247], v1, s[36:39], s42 offen offset:1024 nt
  v_mov_b32_dpp v14, v38 quad_perm:[3,3,3,3] row_mask:0xf bank_mask:0x5
  v_mov_b32_dpp v15, v37 quad_perm:[0,0,0,0] row_mask:0xf bank_mask:0xa
  v_smfmac_f32_16x16x64_bf16 v[24:27], v[16:19], a[248:255], v8
  s_waitcnt vmcnt(27)
  s_cbranch_vccnz L_w63
  s_waitcnt vmcnt(17)
L_w63:
  buffer_load_dwordx4 a[248:251], v1, s[36:39], s42 offen offset:2048 nt
  s_waitcnt vmcnt(27)
  s_cbranch_vccnz L_w64
  s_waitcnt vmcnt(17)
L_w64:
  buffer_load_dwordx4 a[252:255], v1, s[36:39], s42 offen offset:3072 nt
  s_add_u32 s42, s42, s46
  s_and_b32 s47, s42, 0x10000
  s_mul_i32 s47, s47, 3
  s_add_u32 s42, s42, s47
  s_and_b32 s42, s42, 0x1fffff
  v_add_u32 v46, 1, v46
  ds_write_b32 v45, v46
  v_add_u32 v4, 1024, v4
  s_add_u32 s43, s43, 1
  s_cmp_lt_u32 s43, 7
  s_cbranch_scc1 L_vloop
  v_bfe_u32 v44, v0, 1, 3
  v_and_b32 v45, 1, v0
  v_lshl_add_u32 v44, v44, 2, v45
  v_bfe_u32 v45, v0, 4, 1
  v_lshl_add_u32 v44, v44, 1, v45
  v_lshrrev_b32 v45, 5, v0
  v_lshl_add_u32 v44, v44, 2, v45
  v_lshlrev_b32 v44, 3, v44
  v_add_u32 v44, 8832, v44
  v_smfmac_f32_16x16x64_bf16 v[20:23], v[12:15], a[0:7], v8
  v_mov_b32_dpp v16, v37 quad_perm:[1,1,1,1] row_mask:0xf bank_mask:0x5
  v_mov_b32_dpp v17, v38 quad_perm:[2,2,2,2] row_mask:0xf bank_mask:0xa
  v_mov_b32_dpp v18, v38 quad_perm:[2,2,2,2] row_mask:0xf bank_mask:0x5
  v_mov_b32_dpp v19, v37 quad_perm:[1,1,1,1] row_mask:0xf bank_mask:0xa
  v_smfmac_f32_16x16x64_bf16 v[24:27], v[12:15], a[8:15], v8
  ds_read_b32 v36, v4 offset:256
  v_smfmac_f32_16x16x64_bf16 v[20:23], v[16:19], a[16:23], v8
  v_mov_b32_dpp v12, v37 quad_perm:[2,2,2,2] row_mask:0xf bank_mask:0x5
  v_mov_b32_dpp v13, v38 quad_perm:[1,1,1,1] row_mask:0xf bank_mask:0xa
  v_mov_b32_dpp v14, v38 quad_perm:[1,1,1,1] row_mask:0xf bank_mask:0x5
  v_mov_b32_dpp v15, v37 quad_perm:[2,2,2,2] row_mask:0xf bank_mask:0xa
  v_smfmac_f32_16x16x64_bf16 v[24:27], v[16:19], a[24:31], v8
  s_waitcnt lgkmcnt(0)
  v_fma_f32 v36, v36, s45, -v7
  v_exp_f32 v36, v36
  v_smfmac_f32_16x16x64_bf16 v[20:23], v[12:15], a[32:39], v8
  v_mov_b32_dpp v16, v37 quad_perm:[3,3,3,3] row_mask:0xf bank_mask:0x5
  v_mov_b32_dpp v17, v38 quad_perm:[0,0,0,0] row_mask:0xf bank_mask:0xa
  v_and_b32 v41, 0xffff0000, v36
  v_sub_f32 v36, v36, v41
  v_mov_b32_dpp v18, v38 quad_perm:[0,0,0,0] row_mask:0xf bank_mask:0x5
  v_mov_b32_dpp v19, v37 quad_perm:[3,3,3,3] row_mask:0xf bank_mask:0xa
  v_cvt_pk_bf16_f32 v39, v36, v41
  v_smfmac_f32_16x16x64_bf16 v[24:27], v[12:15], a[40:47], v8
  s_nop 0
  v_mov_b32_dpp v40, v39 row_half_mirror row_mask:0xf bank_mask:0xf
  s_nop 0
  v_smfmac_f32_16x16x64_bf16 v[20:23], v[16:19], a[48:55], v8
  v_mov_b32_dpp v12, v39 quad_perm:[0,0,0,0] row_mask:0xf bank_mask:0x5
  v_mov_b32_dpp v13, v40 quad_perm:[3,3,3,3] row_mask:0xf bank_mask:0xa
  v_mov_b32_dpp v14, v40 quad_perm:[3,3,3,3] row_mask:0xf bank_mask:0x5
  v_mov_b32_dpp v15, v39 quad_perm:[0,0,0,0] row_mask:0xf bank_mask:0xa
  v_smfmac_f32_16x16x64_bf16 v[24:27], v[16:19], a[56:63], v8
  s_nop 0
  v_smfmac_f32_16x16x64_bf16 v[20:23], v[12:15], a[64:71], v8
  v_mov_b32_dpp v16, v39 quad_perm:[1,1,1,1] row_mask:0xf bank_mask:0x5
  v_mov_b32_dpp v17, v40 quad_perm:[2,2,2,2] row_mask:0xf bank_mask:0xa
  v_mov_b32_dpp v18, v40 quad_perm:[2,2,2,2] row_mask:0xf bank_mask:0x5
  v_mov_b32_dpp v19, v39 quad_perm:[1,1,1,1] row_mask:0xf bank_mask:0xa
  v_smfmac_f32_16x16x64_bf16 v[24:27], v[12:15], a[72:79], v8
  ds_read_b32 v36, v4 offset:512
  v_smfmac_f32_16x16x64_bf16 v[20:23], v[16:19], a[80:87], v8
  v_mov_b32_dpp v12, v39 quad_perm:[2,2,2,2] row_mask:0xf bank_mask:0x5
  v_mov_b32_dpp v13, v40 quad_perm:[1,1,1,1] row_mask:0xf bank_mask:0xa
  v_mov_b32_dpp v14, v40 quad_perm:[1,1,1,1] row_mask:0xf bank_mask:0x5
  v_mov_b32_dpp v15, v39 quad_perm:[2,2,2,2] row_mask:0xf bank_mask:0xa
  v_smfmac_f32_16x16x64_bf16 v[24:27], v[16:19], a[88:95], v8
  s_waitcnt lgkmcnt(0)
  v_fma_f32 v36, v36, s45, -v7
  v_exp_f32 v36, v36
  v_smfmac_f32_16x16x64_bf16 v[20:23], v[12:15], a[96:103], v8
  v_mov_b32_dpp v16, v39 quad_perm:[3,3,3,3] row_mask:0xf bank_mask:0x5
  v_mov_b32_dpp v17, v40 quad_perm:[0,0,0,0] row_mask:0xf bank_mask:0xa
  v_and_b32 v41, 0xffff0000, v36
  v_sub_f32 v36, v36, v41
  v_mov_b32_dpp v18, v40 quad_perm:[0,0,0,0] row_mask:0xf bank_mask:0x5
  v_mov_b32_dpp v19, v39 quad_perm:[3,3,3,3] row_mask:0xf bank_mask:0xa
  v_cvt_pk_bf16_f32 v37, v36, v41
  v_smfmac_f32_16x16x64_bf16 v[24:27], v[12:15], a[104:111], v8
  s_nop 0
  v_mov_b32_dpp v38, v37 row_half_mirror row_mask:0xf bank_mask:0xf
  s_nop 0
  v_smfmac_f32_16x16x64_bf16 v[20:23], v[16:19], a[112:119], v8
  v_mov_b32_dpp v12, v37 quad_perm:[0,0,0,0] row_mask:0xf bank_mask:0x5
  v_mov_b32_dpp v13, v38 quad_perm:[3,3,3,3] row_mask:0xf bank_mask:0xa
  v_mov_b32_dpp v14, v38 quad_perm:[3,3,3,3] row_mask:0xf bank_mask:0x5
  v_mov_b32_dpp v15, v37 quad_perm:[0,0,0,0] row_mask:0xf bank_mask:0xa
  v_smfmac_f32_16x16x64_bf16 v[24:27], v[16:19], a[120:127], v8
  s_nop 0
  v_smfmac_f32_16x16x64_bf16 v[20:23], v[12:15], a[128:135], v8
  v_mov_b32_dpp v16, v37 quad_perm:[1,1,1,1] row_mask:0xf bank_mask:0x5
  v_mov_b32_dpp v17, v38 quad_perm:[2,2,2,2] row_mask:0xf bank_mask:0xa
  v_mov_b32_dpp v18, v38 quad_perm:[2,2,2,2] row_mask:0xf bank_mask:0x5
  v_mov_b32_dpp v19, v37 quad_perm:[1,1,1,1] row_mask:0xf bank_mask:0xa
  s_waitcnt vmcnt(28)
  v_smfmac_f32_16x16x64_bf16 v[24:27], v[12:15], a[136:143], v8
  ds_read_b32 v36, v4 offset:768
  s_waitcnt vmcnt(26)
  v_smfmac_f32_16x16x64_bf16 v[20:23], v[16:19], a[144:151], v8
  v_mov_b32_dpp v12, v37 quad_perm:[2,2,2,2] row_mask:0xf bank_mask:0x5
  v_mov_b32_dpp v13, v38 quad_perm:[1,1,1,1] row_mask:0xf bank_mask:0xa
  v_mov_b32_dpp v14, v38 quad_perm:[1,1,1,1] row_mask:0xf bank_mask:0x5
  v_mov_b32_dpp v15, v37 quad_perm:[2,2,2,2] row_mask:0xf bank_mask:0xa
  s_waitcnt vmcnt(24)
  v_smfmac_f32_16x16x64_bf16 v[24:27], v[16:19], a[152:159], v8
  s_waitcnt lgkmcnt(0)
  v_fma_f32 v36, v36, s45, -v7
  v_exp_f32 v36, v36
  s_waitcnt vmcnt(22)
  v_smfmac_f32_16x16x64_bf16 v[20:23], v[12:15], a[160:167], v8
  v_mov_b32_dpp v16, v37 quad_perm:[3,3,3,3] row_mask:0xf bank_mask:0x5
  v_mov_b32_dpp v17, v38 quad_perm:[0,0,0,0] row_mask:0xf bank_mask:0xa
  v_and_b32 v41, 0xffff0000, v36
  v_sub_f32 v36, v36, v41
  v_mov_b32_dpp v18, v38 quad_perm:[0,0,0,0] row_mask:0xf bank_mask:0x5
  v_mov_b32_dpp v19, v37 quad_perm:[3,3,3,3] row_mask:0xf bank_mask:0xa
  v_cvt_pk_bf16_f32 v39, v36, v41
  s_waitcnt vmcnt(20)
  v_smfmac_f32_16x16x64_bf16 v[24:27], v[12:15], a[168:175], v8
  s_nop 0
  v_mov_b32_dpp v40, v39 row_half_mirror row_mask:0xf bank_mask:0xf
  s_nop 0
  s_waitcnt vmcnt(18)
  v_smfmac_f32_16x16x64_bf16 v[20:23], v[16:19], a[176:183], v8
  v_mov_b32_dpp v12, v39 quad_perm:[0,0,0,0] row_mask:0xf bank_mask:0x5
  v_mov_b32_dpp v13, v40 quad_perm:[3,3,3,3] row_mask:0xf bank_mask:0xa
  v_mov_b32_dpp v14, v40 quad_perm:[3,3,3,3] row_mask:0xf bank_mask:0x5
  v_mov_b32_dpp v15, v39 quad_perm:[0,0,0,0] row_mask:0xf bank_mask:0xa
  s_waitcnt vmcnt(16)
  v_smfmac_f32_16x16x64_bf16 v[24:27], v[16:19], a[184:191], v8
  s_nop 0
  s_waitcnt vmcnt(14)
  v_smfmac_f32_16x16x64_bf16 v[20:23], v[12:15], a[192:199], v8
  v_mov_b32_dpp v16, v39 quad_perm:[1,1,1,1] row_mask:0xf bank_mask:0x5
  v_mov_b32_dpp v17, v40 quad_perm:[2,2,2,2] row_mask:0xf bank_mask:0xa
  v_mov_b32_dpp v18, v40 quad_perm:[2,2,2,2] row_mask:0xf bank_mask:0x5
  v_mov_b32_dpp v19, v39 quad_perm:[1,1,1,1] row_mask:0xf bank_mask:0xa
  s_waitcnt vmcnt(12)
  v_smfmac_f32_16x16x64_bf16 v[24:27], v[12:15], a[200:207], v8
  s_nop 0
  s_waitcnt vmcnt(10)
  v_smfmac_f32_16x16x64_bf16 v[20:23], v[16:19], a[208:215], v8
  v_mov_b32_dpp v12, v39 quad_perm:[2,2,2,2] row_mask:0xf bank_mask:0x5
  v_mov_b32_dpp v13, v40 quad_perm:[1,1,1,1] row_mask:0xf bank_mask:0xa
  v_mov_b32_dpp v14, v40 quad_perm:[1,1,1,1] row_mask:0xf bank_mask:0x5
  v_mov_b32_dpp v15, v39 quad_perm:[2,2,2,2] row_mask:0xf bank_mask:0xa
  s_waitcnt vmcnt(8)
  v_smfmac_f32_16x16x64_bf16 v[24:27], v[16:19], a[216:223], v8
  s_nop 0
  s_waitcnt vmcnt(6)
  v_smfmac_f32_16x16x64_bf16 v[20:23], v[12:15], a[224:231], v8
  v_mov_b32_dpp v16, v39 quad_perm:[3,3,3,3] row_mask:0xf bank_mask:0x5
  v_mov_b32_dpp v17, v40 quad_perm:[0,0,0,0] row_mask:0xf bank_mask:0xa
  v_mov_b32_dpp v18, v40 quad_perm:[0,0,0,0] row_mask:0xf bank_mask:0x5
  v_mov_b32_dpp v19, v39 quad_perm:[3,3,3,3] row_mask:0xf bank_mask:0xa
  s_waitcnt vmcnt(4)
  v_smfmac_f32_16x16x64_bf16 v[24:27], v[12:15], a[232:239], v8
  s_nop 0
  s_waitcnt vmcnt(2)
  v_smfmac_f32_16x16x64_bf16 v[20:23], v[16:19], a[240:247], v8
  s_waitcnt vmcnt(0)
  v_smfmac_f32_16x16x64_bf16 v[24:27], v[16:19], a[248:255], v8
  s_nop 5
  v_permlane32_swap_b32 v20, v21
  v_permlane32_swap_b32 v22, v23
  v_permlane32_swap_b32 v24, v25
  v_permlane32_swap_b32 v26, v27
  v_add_f32 v20, v20, v25
  v_add_f32 v22, v22, v27
  v_cvt_pk_bf16_f32 v20, v20, 0
  v_cvt_pk_bf16_f32 v22, v22, 0
  ds_write2_b32 v44, v20, v22 offset0:0 offset1:4
  ds_write2_b32 v44, v20, v22 offset0:33 offset1:37
  s_waitcnt lgkmcnt(0)
  s_barrier
  s_cmp_lt_u32 s32, 18
  s_cbranch_scc0 L_sdone
  v_readfirstlane_b32 s80, v9
  s_and_b32 s3, s31, 3
  s_mul_i32 s3, s3, 18
  s_add_u32 s46, s3, s32
  s_lshr_b32 s47, s31, 2
  s_mul_i32 s3, s47, 294912
  s_lshl_b32 s48, s46, 5
  s_add_u32 s3, s3, s48
  s_add_u32 s36, s28, s3
  s_addc_u32 s37, s29, 0
  s_mov_b32 s38, 294912
  s_and_b32 s76, s80, 0xff
  s_bfe_u32 s77, s80, 0x80008
  s_bfe_u32 s78, s80, 0x80010
  s_lshr_b32 s79, s80, 24
  v_lshrrev_b32 v47, 1, v0
  v_and_b32 v46, 1, v0
  v_mul_u32_u24 v45, 9216, v47
  v_lshl_add_u32 v45, v46, 4, v45
  s_movk_i32 s48, 4608
  s_mov_b32 s49, 0x100000
  v_lshrrev_b32 v44, 5, v0
  v_bfe_u32 v47, v0, 4, 1
  v_lshl_add_u32 v44, v47, 1, v44
  v_lshl_add_u32 v44, v46, 2, v44
  v_lshlrev_b32 v44, 1, v44
  s_mul_i32 s3, s47, 1152
  s_lshl_b32 s46, s46, 4
  s_add_u32 s3, s3, s46
  s_add_u32 s52, s24, s3
  s_addc_u32 s53, s25, 0
  s_mov_b32 s54, 16
  s_mov_b32 s55, 0x20000
  s_add_u32 s56, s28, 753664
  s_addc_u32 s57, s29, 0
  s_mov_b32 s58, 4
  s_mov_b32 s59, 0x20000
  v_lshlrev_b32 v43, 2, v0
  s_mov_b32 s50, 0x00030003
  s_mov_b32 s51, 0x00030003
  s_barrier
L_ypoll:
  buffer_load_dwordx4 v[56:59], v45, s[36:39], 0 offen offset:0 sc1
  buffer_load_dwordx4 v[60:63], v45, s[36:39], 0 offen offset:2304 sc1
  buffer_load_dwordx4 v[64:67], v45, s[36:39], s48 offen offset:0 sc1
  buffer_load_dwordx4 v[68:71], v45, s[36:39], s48 offen offset:2304 sc1
  s_sub_u32 s49, s49, 1
  s_waitcnt vmcnt(0)
  s_cbranch_scc1 L_yok
  v_xor_b32 v56, s76, v56
  v_xor_b32 v57, s77, v57
  v_xor_b32 v58, s78, v58
  v_xor_b32 v59, s79, v59
  v_xor_b32 v60, s76, v60
  v_xor_b32 v61, s77, v61
  v_xor_b32 v62, s78, v62
  v_xor_b32 v63, s79, v63
  v_xor_b32 v64, s76, v64
  v_xor_b32 v65, s77, v65
  v_xor_b32 v66, s78, v66
  v_xor_b32 v67, s79, v67
  v_xor_b32 v68, s76, v68
  v_xor_b32 v69, s77, v69
  v_xor_b32 v70, s78, v70
  v_xor_b32 v71, s79, v71
  v_or_b32 v47, v56, v57
  v_or3_b32 v47, v47, v58, v59
  v_or3_b32 v47, v47, v60, v61
  v_or3_b32 v47, v47, v62, v63
  v_or3_b32 v47, v47, v64, v65
  v_or3_b32 v47, v47, v66, v67
  v_or3_b32 v47, v47, v68, v69
  v_or3_b32 v47, v47, v70, v71
  v_and_b32 v47, 0xff, v47
  v_cmp_ne_u32 vcc, 0, v47
  s_and_b64 exec, vcc, vcc
  s_cbranch_scc1 L_ypoll
L_yok:
  s_mov_b64 exec, -1
  v_add_f32 v56, v56, v60
  v_add_f32 v57, v57, v61
  v_add_f32 v58, v58, v62
  v_add_f32 v59, v59, v63
  v_add_f32 v64, v64, v68
  v_add_f32 v65, v65, v69
  v_add_f32 v66, v66, v70
  v_add_f32 v67, v67, v71
  v_add_f32 v56, v56, v64
  v_add_f32 v57, v57, v65
  v_add_f32 v58, v58, v66
  v_add_f32 v59, v59, v67
  s_nop 0
  v_permlane32_swap_b32 v56, v57
  v_permlane32_swap_b32 v58, v59
  v_add_f32 v56, v56, v57
  v_add_f32 v58, v58, v59
  s_nop 1
  v_permlane16_swap_b32 v56, v58
  v_add_f32 v56, v56, v58
  s_nop 1
  v_add_f32_dpp v56, v56, v56 row_ror:8 row_mask:0xf bank_mask:0xf
  s_nop 1
  v_add_f32_dpp v56, v56, v56 row_ror:4 row_mask:0xf bank_mask:0xf
  s_nop 1
  v_add_f32_dpp v56, v56, v56 row_ror:2 row_mask:0xf bank_mask:0xf
  v_cvt_pk_bf16_f32 v56, v56, v56
  s_mov_b64 exec, s[50:51]
  buffer_store_short v56, v44, s[52:55], 0 offen
  s_cmp_eq_u32 s2, 0
  s_cbranch_scc0 L_sdone
  buffer_store_dword v9, v43, s[56:59], 0 offen
L_sdone:
L_end:
  s_endpgm
.p2align 6
L_h0b:
  v_lshl_add_u32 v5, v5, 2, v6
  v_mul_u32_u24 v3, 1152, v5
  v_and_b32 v4, 7, v0
  v_lshl_add_u32 v3, v4, 4, v3
  v_lshrrev_b32 v5, 5, v0
  v_bfe_u32 v7, v0, 2, 1
  v_lshl_add_u32 v5, v7, 1, v5
  v_bfe_u32 v7, v0, 3, 1
  v_lshl_add_u32 v5, v5, 1, v7
  v_bfe_u32 v7, v0, 4, 1
  v_lshl_add_u32 v5, v5, 1, v7
  v_lshlrev_b32 v5, 4, v5
  v_and_b32 v16, 3, v0
  v_mul_u32_u24 v16, 0x5555, v16
  v_lshlrev_b32 v4, 5, v4
  v_bfe_u32 v6, v0, 4, 1
  v_lshl_add_u32 v4, v6, 4, v4
  v_lshrrev_b32 v6, 5, v0
  v_bfe_u32 v7, v0, 3, 1
  v_lshl_add_u32 v6, v7, 1, v6
  v_lshl_add_u32 v4, v6, 8, v4
  v_and_b32 v6, 1, v0
  v_lshlrev_b32 v6, 4, v6
  v_mov_b32 v7, 0xffff
  v_lshlrev_b32 v6, v6, v7
  v_lshrrev_b32 v7, 4, v0
  s_mov_b32 s3, 0x02020202
  v_mul_lo_u32 v7, s3, v7
  v_add_u32 v7, 0x01000100, v7
  s_mov_b32 s3, 0x0c0c0c0c
  v_bfi_b32 v6, v6, v7, s3
  v_mov_b32 v8, s3
  v_bfe_u32 v7, v0, 1, 2
  v_cmp_eq_u32 vcc, 0, v7
  s_nop 1
  v_cndmask_b32 v12, v8, v6, vcc
  v_cmp_eq_u32 vcc, 1, v7
  s_nop 1
  v_cndmask_b32 v13, v8, v6, vcc
  v_cmp_eq_u32 vcc, 2, v7
  s_nop 1
  v_cndmask_b32 v14, v8, v6, vcc
  v_cmp_eq_u32 vcc, 3, v7
  s_nop 1
  v_cndmask_b32 v15, v8, v6, vcc
  s_add_u32 s56, s28, 1048576
  s_addc_u32 s57, s29, 0
  s_mov_b32 s58, 262144
  s_lshl_b32 s3, s33, 3
  s_add_u32 s3, s3, s43
  s_lshl_b32 s3, s3, 10
  v_lshl_add_u32 v51, v0, 4, s3
  v_and_b32 v50, 31, v0
  s_lshl_b32 s3, s33, 4
  s_add_u32 s3, s3, s34
  s_lshl_b32 s3, s3, 9
  v_lshl_add_u32 v50, v50, 4, s3
  v_lshrrev_b32 v49, 5, v0
  v_lshl_add_u32 v50, v49, 10, v50
  v_and_b32 v6, 15, v0
  v_bfe_u32 v7, v0, 4, 1
  v_lshlrev_b32 v6, 4, v6
  v_lshl_add_u32 v6, v7, 3, v6
  v_lshl_add_u32 v6, v49, 2, v6
  s_waitcnt lgkmcnt(0)
  s_add_u32 s80, s80, 0x11010101
  s_and_b32 s76, s80, 0xff
  s_bfe_u32 s77, s80, 0x80008
  s_bfe_u32 s78, s80, 0x80010
  s_lshr_b32 s79, s80, 24
  s_getreg_b32 s42, hwreg(HW_REG_XCC_ID, 0, 4)
  s_and_b32 s45, s79, 0xf0
  s_or_b32 s45, s45, s42
  s_waitcnt vmcnt(18)
  v_perm_b32 v20, v65, v64, v12
  v_perm_b32 v21, v65, v64, v13
  v_perm_b32 v22, v65, v64, v14
  v_perm_b32 v23, v65, v64, v15
  v_perm_b32 v24, v67, v66, v12
  v_perm_b32 v25, v67, v66, v13
  v_perm_b32 v26, v67, v66, v14
  v_perm_b32 v27, v67, v66, v15
  s_waitcnt vmcnt(17)
  v_mfma_f32_16x16x32_bf16 v[28:31], v[20:23], a[0:3], 0
  v_perm_b32 v20, v69, v68, v12
  v_perm_b32 v21, v69, v68, v13
  v_perm_b32 v22, v69, v68, v14
  v_perm_b32 v23, v69, v68, v15
  s_waitcnt vmcnt(16)
  v_mfma_f32_16x16x32_bf16 v[28:31], v[24:27], a[4:7], v[28:31]
  v_perm_b32 v24, v71, v70, v12
  v_perm_b32 v25, v71, v70, v13
  v_perm_b32 v26, v71, v70, v14
  v_perm_b32 v27, v71, v70, v15
  s_waitcnt vmcnt(15)
  v_mfma_f32_16x16x32_bf16 v[28:31], v[20:23], a[8:11], v[28:31]
  v_perm_b32 v20, v73, v72, v12
  v_perm_b32 v21, v73, v72, v13
  v_perm_b32 v22, v73, v72, v14
  v_perm_b32 v23, v73, v72, v15
  s_waitcnt vmcnt(14)
  v_mfma_f32_16x16x32_bf16 v[28:31], v[24:27], a[12:15], v[28:31]
  v_perm_b32 v24, v75, v74, v12
  v_perm_b32 v25, v75, v74, v13
  v_perm_b32 v26, v75, v74, v14
  v_perm_b32 v27, v75, v74, v15
  s_waitcnt vmcnt(13)
  v_mfma_f32_16x16x32_bf16 v[28:31], v[20:23], a[16:19], v[28:31]
  v_perm_b32 v20, v77, v76, v12
  v_perm_b32 v21, v77, v76, v13
  v_perm_b32 v22, v77, v76, v14
  v_perm_b32 v23, v77, v76, v15
  s_waitcnt vmcnt(12)
  v_mfma_f32_16x16x32_bf16 v[28:31], v[24:27], a[20:23], v[28:31]
  v_perm_b32 v24, v79, v78, v12
  v_perm_b32 v25, v79, v78, v13
  v_perm_b32 v26, v79, v78, v14
  v_perm_b32 v27, v79, v78, v15
  s_waitcnt vmcnt(11)
  v_mfma_f32_16x16x32_bf16 v[28:31], v[20:23], a[24:27], v[28:31]
  v_perm_b32 v20, v81, v80, v12
  v_perm_b32 v21, v81, v80, v13
  v_perm_b32 v22, v81, v80, v14
  v_perm_b32 v23, v81, v80, v15
  s_waitcnt vmcnt(10)
  v_mfma_f32_16x16x32_bf16 v[28:31], v[24:27], a[28:31], v[28:31]
  v_perm_b32 v24, v83, v82, v12
  v_perm_b32 v25, v83, v82, v13
  v_perm_b32 v26, v83, v82, v14
  v_perm_b32 v27, v83, v82, v15
  s_waitcnt vmcnt(9)
  v_mfma_f32_16x16x32_bf16 v[28:31], v[20:23], a[32:35], v[28:31]
  v_perm_b32 v20, v85, v84, v12
  v_perm_b32 v21, v85, v84, v13
  v_perm_b32 v22, v85, v84, v14
  v_perm_b32 v23, v85, v84, v15
  s_waitcnt vmcnt(8)
  v_mfma_f32_16x16x32_bf16 v[28:31], v[24:27], a[36:39], v[28:31]
  v_perm_b32 v24, v87, v86, v12
  v_perm_b32 v25, v87, v86, v13
  v_perm_b32 v26, v87, v86, v14
  v_perm_b32 v27, v87, v86, v15
  s_waitcnt vmcnt(7)
  v_mfma_f32_16x16x32_bf16 v[28:31], v[20:23], a[40:43], v[28:31]
  v_perm_b32 v20, v89, v88, v12
  v_perm_b32 v21, v89, v88, v13
  v_perm_b32 v22, v89, v88, v14
  v_perm_b32 v23, v89, v88, v15
  s_waitcnt vmcnt(6)
  v_mfma_f32_16x16x32_bf16 v[28:31], v[24:27], a[44:47], v[28:31]
  v_perm_b32 v24, v91, v90, v12
  v_perm_b32 v25, v91, v90, v13
  v_perm_b32 v26, v91, v90, v14
  v_perm_b32 v27, v91, v90, v15
  s_waitcnt vmcnt(5)
  v_mfma_f32_16x16x32_bf16 v[28:31], v[20:23], a[48:51], v[28:31]
  v_perm_b32 v20, v93, v92, v12
  v_perm_b32 v21, v93, v92, v13
  v_perm_b32 v22, v93, v92, v14
  v_perm_b32 v23, v93, v92, v15
  s_waitcnt vmcnt(4)
  v_mfma_f32_16x16x32_bf16 v[28:31], v[24:27], a[52:55], v[28:31]
  v_perm_b32 v24, v95, v94, v12
  v_perm_b32 v25, v95, v94, v13
  v_perm_b32 v26, v95, v94, v14
  v_perm_b32 v27, v95, v94, v15
  s_waitcnt vmcnt(3)
  v_mfma_f32_16x16x32_bf16 v[28:31], v[20:23], a[56:59], v[28:31]
  v_perm_b32 v20, v97, v96, v12
  v_perm_b32 v21, v97, v96, v13
  v_perm_b32 v22, v97, v96, v14
  v_perm_b32 v23, v97, v96, v15
  s_waitcnt vmcnt(2)
  v_mfma_f32_16x16x32_bf16 v[28:31], v[24:27], a[60:63], v[28:31]
  v_perm_b32 v24, v99, v98, v12
  v_perm_b32 v25, v99, v98, v13
  v_perm_b32 v26, v99, v98, v14
  v_perm_b32 v27, v99, v98, v15
  s_waitcnt vmcnt(1)
  v_mfma_f32_16x16x32_bf16 v[28:31], v[20:23], a[64:67], v[28:31]
  s_waitcnt vmcnt(0)
  v_mfma_f32_16x16x32_bf16 v[28:31], v[24:27], a[68:71], v[28:31]
  s_movk_i32 s3, 0x1000
  s_mov_b32 s47, 24
  v_mov_b32 v7, 0xffffff00
  v_mov_b32 v52, s80
  v_mov_b32 v53, 1
  s_nop 2
  v_and_or_b32 v28, v28, v7, s76
  v_and_or_b32 v29, v29, v7, s77
  v_and_or_b32 v30, v30, v7, s78
  v_and_or_b32 v31, v31, v7, s45
  buffer_store_dwordx4 v[28:31], v51, s[56:59], 0 offen
  s_barrier
L_qpoll:
  buffer_load_dwordx4 v[64:67], v50, s[56:59], 0 offen offset:0 sc1
  buffer_load_dwordx4 v[68:71], v50, s[56:59], 0 offen offset:2048 sc1
  buffer_load_dwordx4 v[72:75], v50, s[56:59], s3 offen offset:0 sc1
  buffer_load_dwordx4 v[76:79], v50, s[56:59], s3 offen offset:2048 sc1
  s_sub_u32 s47, s47, 1
  s_waitcnt vmcnt(0)
  s_cbranch_scc1 L_qfar
  v_xor_b32 v64, s76, v64
  v_xor_b32 v65, s77, v65
  v_xor_b32 v66, s78, v66
  v_xor_b32 v67, s45, v67
  v_xor_b32 v68, s76, v68
  v_xor_b32 v69, s77, v69
  v_xor_b32 v70, s78, v70
  v_xor_b32 v71, s45, v71
  v_xor_b32 v72, s76, v72
  v_xor_b32 v73, s77, v73
  v_xor_b32 v74, s78, v74
  v_xor_b32 v75, s45, v75
  v_xor_b32 v76, s76, v76
  v_xor_b32 v77, s77, v77
  v_xor_b32 v78, s78, v78
  v_xor_b32 v79, s45, v79
  v_or_b32 v7, v64, v65
  v_or3_b32 v7, v7, v66, v67
  v_or3_b32 v7, v7, v68, v69
  v_or3_b32 v7, v7, v70, v71
  v_or3_b32 v7, v7, v72, v73
  v_or3_b32 v7, v7, v74, v75
  v_or3_b32 v7, v7, v76, v77
  v_or3_b32 v7, v7, v78, v79
  v_and_b32 v7, 0xff, v7
  v_cmp_ne_u32 vcc, 0, v7
  s_cbranch_vccnz L_qpoll
L_qok:
  v_add_f32 v64, v64, v68
  v_add_f32 v65, v65, v69
  v_add_f32 v66, v66, v70
  v_add_f32 v67, v67, v71
  v_add_f32 v72, v72, v76
  v_add_f32 v73, v73, v77
  v_add_f32 v74, v74, v78
  v_add_f32 v75, v75, v79
  v_add_f32 v64, v64, v72
  v_add_f32 v65, v65, v73
  v_add_f32 v66, v66, v74
  v_add_f32 v67, v67, v75
  v_mov_b32 v7, 8768
  v_permlane32_swap_b32 v64, v66
  v_permlane32_swap_b32 v65, v67
  v_add_f32 v64, v64, v66
  v_add_f32 v65, v65, v67
  v_cvt_pk_bf16_f32 v64, v64, v65
  ds_write_b32 v6, v64 offset:8512
  ds_write_b64 v7, v[52:53] offset:8
  s_branch L_hbar1
L_qfar:
  buffer_store_dwordx4 v[28:31], v51, s[56:59], 0 offen sc1
  s_mov_b32 s47, 0x40000
  v_mov_b32 v53, 0
L_qpoll2:
  buffer_load_dwordx4 v[64:67], v50, s[56:59], 0 offen offset:0 sc1
  buffer_load_dwordx4 v[68:71], v50, s[56:59], 0 offen offset:2048 sc1
  buffer_load_dwordx4 v[72:75], v50, s[56:59], s3 offen offset:0 sc1
  buffer_load_dwordx4 v[76:79], v50, s[56:59], s3 offen offset:2048 sc1
  s_sub_u32 s47, s47, 1
  s_waitcnt vmcnt(0)
  s_cbranch_scc1 L_qok
  v_xor_b32 v64, s76, v64
  v_xor_b32 v65, s77, v65
  v_xor_b32 v66, s78, v66
  v_xor_b32 v67, s45, v67
  v_and_b32 v67, -16, v67
  v_xor_b32 v68, s76, v68
  v_xor_b32 v69, s77, v69
  v_xor_b32 v70, s78, v70
  v_xor_b32 v71, s45, v71
  v_and_b32 v71, -16, v71
  v_xor_b32 v72, s76, v72
  v_xor_b32 v73, s77, v73
  v_xor_b32 v74, s78, v74
  v_xor_b32 v75, s45, v75
  v_and_b32 v75, -16, v75
  v_xor_b32 v76, s76, v76
  v_xor_b32 v77, s77, v77
  v_xor_b32 v78, s78, v78
  v_xor_b32 v79, s45, v79
  v_and_b32 v79, -16, v79
  v_or_b32 v7, v64, v65
  v_or3_b32 v7, v7, v66, v67
  v_or3_b32 v7, v7, v68, v69
  v_or3_b32 v7, v7, v70, v71
  v_or3_b32 v7, v7, v72, v73
  v_or3_b32 v7, v7, v74, v75
  v_or3_b32 v7, v7, v76, v77
  v_or3_b32 v7, v7, v78, v79
  v_and_b32 v7, 0xff, v7
  v_cmp_ne_u32 vcc, 0, v7
  s_cbranch_vccnz L_qpoll2
  s_branch L_qok
L_noq:
  s_waitcnt lgkmcnt(0)
  s_cmp_eq_u32 s30, 3
  s_cbranch_scc0 L_pre1
  s_mul_i32 s3, s44, 2304
  s_add_u32 s56, s28, s3
  s_addc_u32 s57, s29, 0
  s_mov_b32 s58, 2304
  v_lshlrev_b32 v40, 7, v0
  buffer_load_dword v44, v40, s[56:59], 0 offen
  s_mul_i32 s3, s34, 1152
  s_add_u32 s52, s4, s3
  s_addc_u32 s53, s5, 0
  s_mov_b32 s54, 1152
  s_add_u32 s48, s22, 0
  s_addc_u32 s49, s23, 0
  s_mov_b32 s50, 1152
  s_mov_b32 s51, 0x20000
  v_lshlrev_b32 v19, 5, v0
  buffer_load_dwordx4 v[68:71], v19, s[52:55], 0 offen
  buffer_load_dwordx4 v[72:75], v19, s[52:55], 0 offen offset:16
  buffer_load_dwordx4 v[76:79], v19, s[48:51], 0 offen
  buffer_load_dwordx4 v[80:83], v19, s[48:51], 0 offen offset:16
  v_lshl_add_u32 v5, v5, 2, v6
  v_mul_u32_u24 v3, 1152, v5
  v_and_b32 v4, 7, v0
  v_lshl_add_u32 v3, v4, 4, v3
  v_lshrrev_b32 v5, 5, v0
  v_bfe_u32 v7, v0, 2, 1
  v_lshl_add_u32 v5, v7, 1, v5
  v_bfe_u32 v7, v0, 3, 1
  v_lshl_add_u32 v5, v5, 1, v7
  v_bfe_u32 v7, v0, 4, 1
  v_lshl_add_u32 v5, v5, 1, v7
  v_lshlrev_b32 v5, 4, v5
  v_and_b32 v16, 3, v0
  v_mul_u32_u24 v16, 0x5555, v16
  v_lshlrev_b32 v4, 5, v4
  v_bfe_u32 v6, v0, 4, 1
  v_lshl_add_u32 v4, v6, 4, v4
  v_lshrrev_b32 v6, 5, v0
  v_bfe_u32 v7, v0, 3, 1
  v_lshl_add_u32 v6, v7, 1, v6
  v_lshl_add_u32 v4, v6, 8, v4
  v_and_b32 v6, 1, v0
  v_lshlrev_b32 v6, 4, v6
  v_mov_b32 v7, 0xffff
  v_lshlrev_b32 v6, v6, v7
  v_lshrrev_b32 v7, 4, v0
  s_mov_b32 s3, 0x02020202
  v_mul_lo_u32 v7, s3, v7
  v_add_u32 v7, 0x01000100, v7
  s_mov_b32 s3, 0x0c0c0c0c
  v_bfi_b32 v6, v6, v7, s3
  v_mov_b32 v8, s3
  v_bfe_u32 v7, v0, 1, 2
  v_cmp_eq_u32 vcc, 0, v7
  s_nop 1
  v_cndmask_b32 v12, v8, v6, vcc
  v_cmp_eq_u32 vcc, 1, v7
  s_nop 1
  v_cndmask_b32 v13, v8, v6, vcc
  v_cmp_eq_u32 vcc, 2, v7
  s_nop 1
  v_cndmask_b32 v14, v8, v6, vcc
  v_cmp_eq_u32 vcc, 3, v7
  s_nop 1
  v_cndmask_b32 v15, v8, v6, vcc
  v_mov_b32 v19, 0
  s_waitcnt vmcnt(0)
  v_lshlrev_b32 v6, 16, v68
  v_lshlrev_b32 v7, 16, v76
  v_fmac_f32 v19, v6, v7
  v_and_b32 v6, 0xffff0000, v68
  v_and_b32 v7, 0xffff0000, v76
  v_fmac_f32 v19, v6, v7
  v_lshlrev_b32 v6, 16, v69
  v_lshlrev_b32 v7, 16, v77
  v_fmac_f32 v19, v6, v7
  v_and_b32 v6, 0xffff0000, v69
  v_and_b32 v7, 0xffff0000, v77
  v_fmac_f32 v19, v6, v7
  v_lshlrev_b32 v6, 16, v70
  v_lshlrev_b32 v7, 16, v78
  v_fmac_f32 v19, v6, v7
  v_and_b32 v6, 0xffff0000, v70
  v_and_b32 v7, 0xffff0000, v78
  v_fmac_f32 v19, v6, v7
  v_lshlrev_b32 v6, 16, v71
  v_lshlrev_b32 v7, 16, v79
  v_fmac_f32 v19, v6, v7
  v_and_b32 v6, 0xffff0000, v71
  v_and_b32 v7, 0xffff0000, v79
  v_fmac_f32 v19, v6, v7
  v_lshlrev_b32 v6, 16, v72
  v_lshlrev_b32 v7, 16, v80
  v_fmac_f32 v19, v6, v7
  v_and_b32 v6, 0xffff0000, v72
  v_and_b32 v7, 0xffff0000, v80
  v_fmac_f32 v19, v6, v7
  v_lshlrev_b32 v6, 16, v73
  v_lshlrev_b32 v7, 16, v81
  v_fmac_f32 v19, v6, v7
  v_and_b32 v6, 0xffff0000, v73
  v_and_b32 v7, 0xffff0000, v81
  v_fmac_f32 v19, v6, v7
  v_lshlrev_b32 v6, 16, v74
  v_lshlrev_b32 v7, 16, v82
  v_fmac_f32 v19, v6, v7
  v_and_b32 v6, 0xffff0000, v74
  v_and_b32 v7, 0xffff0000, v82
  v_fmac_f32 v19, v6, v7
  v_lshlrev_b32 v6, 16, v75
  v_lshlrev_b32 v7, 16, v83
  v_fmac_f32 v19, v6, v7
  v_and_b32 v6, 0xffff0000, v75
  v_and_b32 v7, 0xffff0000, v83
  v_fmac_f32 v19, v6, v7
  s_nop 1
  v_add_f32_dpp v19, v19, v19 row_ror:1 row_mask:0xf bank_mask:0xf
  s_nop 1
  v_add_f32_dpp v19, v19, v19 row_ror:2 row_mask:0xf bank_mask:0xf
  s_nop 1
  v_add_f32_dpp v19, v19, v19 row_ror:4 row_mask:0xf bank_mask:0xf
  s_nop 1
  v_add_f32_dpp v19, v19, v19 row_ror:8 row_mask:0xf bank_mask:0xf
  s_nop 1
  v_add_f32_dpp v19, v19, v19 row_bcast:15 row_mask:0xa bank_mask:0xf
  s_nop 1
  v_add_f32_dpp v19, v19, v19 row_bcast:31 row_mask:0xc bank_mask:0xf
  s_nop 1
  v_readlane_b32 s3, v19, 63
  v_mov_b32 v19, 0xbfb8aa3b
  s_nop 0
  v_mul_f32 v19, s3, v19
  v_exp_f32 v19, v19
  s_nop 0
  v_add_f32 v19, 1.0, v19
  v_rcp_f32 v19, v19
  v_mov_b32 v7, 8768
  ds_write_b32 v7, v19 offset:16
  s_branch L_pre2
L_pre1:
  s_lshr_b32 s47, s32, 3
  s_and_b32 s83, s31, 1
  s_mul_i32 s83, s83, 3
  s_add_u32 s83, s83, s47
  s_lshl2_add_u32 s47, s31, s47
  s_lshr_b32 s81, s31, 1
  s_add_u32 s81, s81, 32
  s_and_b32 s3, s32, 7
  s_cmp_lt_u32 s3, 6
  s_cselect_b32 s83, s3, s83
  s_cselect_b32 s81, s47, s81
  s_bitcmp1_b32 0xc0808080, s32
  s_cselect_b32 s83, 7, s83
  s_lshl_b32 s3, s81, 8
  s_add_u32 s52, s18, s3
  s_addc_u32 s53, s19, 0
  s_mov_b32 s54, 256
  v_bfe_u32 v9, v0, 4, 1
  v_and_b32 v10, 15, v0
  v_lshlrev_b32 v9, 3, v9
  v_lshl_add_u32 v9, v10, 4, v9
  buffer_load_dwordx2 v[10:11], v9, s[52:55], 0 offen
  s_cmp_eq_u32 s31, 0
  s_cbranch_scc0 L_nozero
  s_lshl_b32 s3, s32, 8
  s_add_u32 s3, s3, 1310720
  s_add_u32 s56, s28, s3
  s_addc_u32 s57, s29, 0
  s_mov_b32 s58, 24580
  v_lshlrev_b32 v40, 13, v0
  v_mov_b32 v41, 0
  buffer_store_dword v41, v40, s[56:59], 0 offen sc1
L_nozero:
  v_lshl_add_u32 v5, v5, 2, v6
  v_mul_u32_u24 v3, 1152, v5
  v_and_b32 v4, 7, v0
  v_lshl_add_u32 v3, v4, 4, v3
  v_lshrrev_b32 v5, 5, v0
  v_bfe_u32 v7, v0, 2, 1
  v_lshl_add_u32 v5, v7, 1, v5
  v_bfe_u32 v7, v0, 3, 1
  v_lshl_add_u32 v5, v5, 1, v7
  v_bfe_u32 v7, v0, 4, 1
  v_lshl_add_u32 v5, v5, 1, v7
  v_lshlrev_b32 v5, 4, v5
  v_and_b32 v16, 3, v0
  v_mul_u32_u24 v16, 0x5555, v16
  v_lshlrev_b32 v4, 5, v4
  v_bfe_u32 v6, v0, 4, 1
  v_lshl_add_u32 v4, v6, 4, v4
  v_lshrrev_b32 v6, 5, v0
  v_bfe_u32 v7, v0, 3, 1
  v_lshl_add_u32 v6, v7, 1, v6
  v_lshl_add_u32 v4, v6, 8, v4
  v_and_b32 v6, 1, v0
  v_lshlrev_b32 v6, 4, v6
  v_mov_b32 v7, 0xffff
  v_lshlrev_b32 v6, v6, v7
  v_lshrrev_b32 v7, 4, v0
  s_mov_b32 s3, 0x02020202
  v_mul_lo_u32 v7, s3, v7
  v_add_u32 v7, 0x01000100, v7
  s_mov_b32 s3, 0x0c0c0c0c
  v_bfi_b32 v6, v6, v7, s3
  v_mov_b32 v8, s3
  v_bfe_u32 v7, v0, 1, 2
  v_cmp_eq_u32 vcc, 0, v7
  s_nop 1
  v_cndmask_b32 v12, v8, v6, vcc
  v_cmp_eq_u32 vcc, 1, v7
  s_nop 1
  v_cndmask_b32 v13, v8, v6, vcc
  v_cmp_eq_u32 vcc, 2, v7
  s_nop 1
  v_cndmask_b32 v14, v8, v6, vcc
  v_cmp_eq_u32 vcc, 3, v7
  s_nop 1
  v_cndmask_b32 v15, v8, v6, vcc
  v_mov_b32 v40, 0
  v_mov_b32 v41, 0
  v_mov_b32 v42, 0
  v_mov_b32 v43, 0
  v_lshlrev_b32 v6, 4, v0
  ds_write_b128 v6, v[40:43] offset:8832
  ds_write_b128 v6, v[40:43] offset:9856
L_pre2:
  s_barrier
L_hbar1:
  s_waitcnt vmcnt(0) lgkmcnt(0)
  s_barrier
  v_mov_b32 v17, 8768
  ds_read_b64 v[6:7], v17 offset:8
  ds_read_b32 v19, v17 offset:16
  s_sub_u32 s46, s30, 1
  s_mov_b32 s52, s4
  s_mov_b32 s53, s5
  s_mov_b32 s54, 2304
  s_mov_b32 s51, 0x20000
  s_waitcnt lgkmcnt(0)
  v_readfirstlane_b32 s80, v6
  v_readfirstlane_b32 s89, v7
  v_lshlrev_b32 v1, 4, v0
  s_and_b32 s76, s80, 0xff
  s_bfe_u32 s77, s80, 0x80008
  s_bfe_u32 s78, s80, 0x80010
  s_lshr_b32 s79, s80, 24
  s_lshr_b32 s47, s32, 3
  s_and_b32 s83, s31, 1
  s_mul_i32 s83, s83, 3
  s_add_u32 s83, s83, s47
  s_lshl2_add_u32 s47, s31, s47
  s_lshr_b32 s81, s31, 1
  s_add_u32 s81, s81, 32
  s_and_b32 s3, s32, 7
  s_cmp_lt_u32 s3, 6
  s_cselect_b32 s83, s3, s83
  s_cselect_b32 s81, s47, s81
  s_bitcmp1_b32 0xc0808080, s32
  s_cselect_b32 s83, 7, s83
  s_mul_i32 s3, s81, 3072
  s_add_u32 s3, s3, 589824
  s_add_u32 s48, s28, s3
  s_addc_u32 s49, s29, 0
  s_mov_b32 s50, 3072
  s_cmp_eq_u32 s46, 1
  s_cselect_b32 s83, s83, 7
  s_cmp_lt_u32 s83, 3
  s_cbranch_scc0 L_wo
  v_bfe_u32 v7, v0, 3, 1
  v_mul_u32_u24 v2, 1152, v7
  s_mul_i32 s47, s83, 384
  buffer_load_dwordx4 v[64:67], v2, s[52:55], s47 offen offset:0
  buffer_load_dwordx4 v[68:71], v2, s[52:55], s47 offen offset:16
  buffer_load_dwordx4 v[72:75], v2, s[52:55], s47 offen offset:32
  buffer_load_dwordx4 v[76:79], v2, s[52:55], s47 offen offset:48
  buffer_load_dwordx4 v[80:83], v2, s[52:55], s47 offen offset:64
  buffer_load_dwordx4 v[84:87], v2, s[52:55], s47 offen offset:80
  buffer_load_dwordx4 v[88:91], v2, s[52:55], s47 offen offset:96
  buffer_load_dwordx4 v[92:95], v2, s[52:55], s47 offen offset:112
  buffer_load_dwordx4 v[96:99], v2, s[52:55], s47 offen offset:128
  buffer_load_dwordx4 v[100:103], v2, s[52:55], s47 offen offset:144
  buffer_load_dwordx4 v[104:107], v2, s[52:55], s47 offen offset:160
  buffer_load_dwordx4 v[108:111], v2, s[52:55], s47 offen offset:176
  buffer_load_dwordx4 v[112:115], v2, s[52:55], s47 offen offset:192
  buffer_load_dwordx4 v[116:119], v2, s[52:55], s47 offen offset:208
  buffer_load_dwordx4 v[120:123], v2, s[52:55], s47 offen offset:224
  buffer_load_dwordx4 v[124:127], v2, s[52:55], s47 offen offset:240
  buffer_load_dwordx4 v[128:131], v2, s[52:55], s47 offen offset:256
  buffer_load_dwordx4 v[132:135], v2, s[52:55], s47 offen offset:272
  buffer_load_dwordx4 v[136:139], v2, s[52:55], s47 offen offset:288
  buffer_load_dwordx4 v[140:143], v2, s[52:55], s47 offen offset:304
  buffer_load_dwordx4 v[144:147], v2, s[52:55], s47 offen offset:320
  buffer_load_dwordx4 v[148:151], v2, s[52:55], s47 offen offset:336
  buffer_load_dwordx4 v[152:155], v2, s[52:55], s47 offen offset:352
  buffer_load_dwordx4 v[156:159], v2, s[52:55], s47 offen offset:368
  ds_read_b128 a[0:3], v1 offset:16384
  ds_read_b128 a[4:7], v1 offset:17408
  ds_read_b128 a[8:11], v1 offset:18432
  ds_read_b128 a[12:15], v1 offset:19456
  ds_read_b128 a[16:19], v1 offset:20480
  ds_read_b128 a[20:23], v1 offset:21504
  ds_read_b128 a[24:27], v1 offset:22528
  ds_read_b128 a[28:31], v1 offset:23552
  ds_read_b128 a[32:35], v1 offset:24576
  ds_read_b128 a[36:39], v1 offset:25600
  ds_read_b128 a[40:43], v1 offset:26624
  ds_read_b128 a[44:47], v1 offset:27648
  ds_read_b128 a[48:51], v1 offset:28672
  ds_read_b128 a[52:55], v1 offset:29696
  ds_read_b128 a[56:59], v1 offset:30720
  ds_read_b128 a[60:63], v1 offset:31744
  ds_read_b128 a[64:67], v1 offset:32768
  ds_read_b128 a[68:71], v1 offset:33792
  ds_read_b128 a[72:75], v1 offset:34816
  ds_read_b128 a[76:79], v1 offset:35840
  ds_read_b128 a[80:83], v1 offset:36864
  ds_read_b128 a[84:87], v1 offset:37888
  ds_read_b128 a[88:91], v1 offset:38912
  ds_read_b128 a[92:95], v1 offset:39936
  ds_read_b128 a[96:99], v1 offset:40960
  ds_read_b128 a[100:103], v1 offset:41984
  ds_read_b128 a[104:107], v1 offset:43008
  ds_read_b128 a[108:111], v1 offset:44032
  ds_read_b128 a[112:115], v1 offset:45056
  ds_read_b128 a[116:119], v1 offset:46080
  ds_read_b128 a[120:123], v1 offset:47104
  ds_read_b128 a[124:127], v1 offset:48128
  ds_read_b128 a[128:131], v1 offset:49152
  ds_read_b128 a[132:135], v1 offset:50176
  ds_read_b128 a[136:139], v1 offset:51200
  ds_read_b128 a[140:143], v1 offset:52224
  ds_read_b128 a[144:147], v1 offset:53248
  ds_read_b128 a[148:151], v1 offset:54272
  ds_read_b128 a[152:155], v1 offset:55296
  ds_read_b128 a[156:159], v1 offset:56320
  ds_read_b128 a[160:163], v1 offset:57344
  ds_read_b128 a[164:167], v1 offset:58368
  ds_read_b128 a[168:171], v1 offset:59392
  ds_read_b128 a[172:175], v1 offset:60416
  ds_read_b128 a[176:179], v1 offset:61440
  ds_read_b128 a[180:183], v1 offset:62464
  ds_read_b128 a[184:187], v1 offset:63488
  ds_read_b128 a[188:191], v1 offset:64512
  s_waitcnt lgkmcnt(0)
  s_waitcnt vmcnt(0)
  v_perm_b32 v20, v65, v64, v12
  v_perm_b32 v21, v65, v64, v13
  v_perm_b32 v22, v65, v64, v14
  v_perm_b32 v23, v65, v64, v15
  v_perm_b32 v24, v67, v66, v12
  v_perm_b32 v25, v67, v66, v13
  v_perm_b32 v26, v67, v66, v14
  v_perm_b32 v27, v67, v66, v15
  v_mfma_f32_16x16x32_bf16 v[28:31], v[20:23], a[0:3], 0
  v_perm_b32 v20, v69, v68, v12
  v_perm_b32 v21, v69, v68, v13
  v_perm_b32 v22, v69, v68, v14
  v_perm_b32 v23, v69, v68, v15
  v_mfma_f32_16x16x32_bf16 v[28:31], v[24:27], a[4:7], v[28:31]
  v_perm_b32 v24, v71, v70, v12
  v_perm_b32 v25, v71, v70, v13
  v_perm_b32 v26, v71, v70, v14
  v_perm_b32 v27, v71, v70, v15
  v_mfma_f32_16x16x32_bf16 v[28:31], v[20:23], a[8:11], v[28:31]
  v_perm_b32 v20, v73, v72, v12
  v_perm_b32 v21, v73, v72, v13
  v_perm_b32 v22, v73, v72, v14
  v_perm_b32 v23, v73, v72, v15
  v_mfma_f32_16x16x32_bf16 v[28:31], v[24:27], a[12:15], v[28:31]
  v_perm_b32 v24, v75, v74, v12
  v_perm_b32 v25, v75, v74, v13
  v_perm_b32 v26, v75, v74, v14
  v_perm_b32 v27, v75, v74, v15
  v_mfma_f32_16x16x32_bf16 v[28:31], v[20:23], a[16:19], v[28:31]
  v_perm_b32 v20, v77, v76, v12
  v_perm_b32 v21, v77, v76, v13
  v_perm_b32 v22, v77, v76, v14
  v_perm_b32 v23, v77, v76, v15
  v_mfma_f32_16x16x32_bf16 v[28:31], v[24:27], a[20:23], v[28:31]
  v_perm_b32 v24, v79, v78, v12
  v_perm_b32 v25, v79, v78, v13
  v_perm_b32 v26, v79, v78, v14
  v_perm_b32 v27, v79, v78, v15
  v_mfma_f32_16x16x32_bf16 v[28:31], v[20:23], a[24:27], v[28:31]
  v_perm_b32 v20, v81, v80, v12
  v_perm_b32 v21, v81, v80, v13
  v_perm_b32 v22, v81, v80, v14
  v_perm_b32 v23, v81, v80, v15
  v_mfma_f32_16x16x32_bf16 v[28:31], v[24:27], a[28:31], v[28:31]
  v_perm_b32 v24, v83, v82, v12
  v_perm_b32 v25, v83, v82, v13
  v_perm_b32 v26, v83, v82, v14
  v_perm_b32 v27, v83, v82, v15
  v_mfma_f32_16x16x32_bf16 v[28:31], v[20:23], a[32:35], v[28:31]
  v_perm_b32 v20, v85, v84, v12
  v_perm_b32 v21, v85, v84, v13
  v_perm_b32 v22, v85, v84, v14
  v_perm_b32 v23, v85, v84, v15
  v_mfma_f32_16x16x32_bf16 v[28:31], v[24:27], a[36:39], v[28:31]
  v_perm_b32 v24, v87, v86, v12
  v_perm_b32 v25, v87, v86, v13
  v_perm_b32 v26, v87, v86, v14
  v_perm_b32 v27, v87, v86, v15
  v_mfma_f32_16x16x32_bf16 v[28:31], v[20:23], a[40:43], v[28:31]
  v_perm_b32 v20, v89, v88, v12
  v_perm_b32 v21, v89, v88, v13
  v_perm_b32 v22, v89, v88, v14
  v_perm_b32 v23, v89, v88, v15
  v_mfma_f32_16x16x32_bf16 v[28:31], v[24:27], a[44:47], v[28:31]
  v_perm_b32 v24, v91, v90, v12
  v_perm_b32 v25, v91, v90, v13
  v_perm_b32 v26, v91, v90, v14
  v_perm_b32 v27, v91, v90, v15
  v_mfma_f32_16x16x32_bf16 v[28:31], v[20:23], a[48:51], v[28:31]
  v_perm_b32 v20, v93, v92, v12
  v_perm_b32 v21, v93, v92, v13
  v_perm_b32 v22, v93, v92, v14
  v_perm_b32 v23, v93, v92, v15
  v_mfma_f32_16x16x32_bf16 v[28:31], v[24:27], a[52:55], v[28:31]
  v_perm_b32 v24, v95, v94, v12
  v_perm_b32 v25, v95, v94, v13
  v_perm_b32 v26, v95, v94, v14
  v_perm_b32 v27, v95, v94, v15
  v_mfma_f32_16x16x32_bf16 v[28:31], v[20:23], a[56:59], v[28:31]
  v_perm_b32 v20, v97, v96, v12
  v_perm_b32 v21, v97, v96, v13
  v_perm_b32 v22, v97, v96, v14
  v_perm_b32 v23, v97, v96, v15
  v_mfma_f32_16x16x32_bf16 v[28:31], v[24:27], a[60:63], v[28:31]
  v_perm_b32 v24, v99, v98, v12
  v_perm_b32 v25, v99, v98, v13
  v_perm_b32 v26, v99, v98, v14
  v_perm_b32 v27, v99, v98, v15
  v_mfma_f32_16x16x32_bf16 v[28:31], v[20:23], a[64:67], v[28:31]
  v_perm_b32 v20, v101, v100, v12
  v_perm_b32 v21, v101, v100, v13
  v_perm_b32 v22, v101, v100, v14
  v_perm_b32 v23, v101, v100, v15
  v_mfma_f32_16x16x32_bf16 v[28:31], v[24:27], a[68:71], v[28:31]
  v_perm_b32 v24, v103, v102, v12
  v_perm_b32 v25, v103, v102, v13
  v_perm_b32 v26, v103, v102, v14
  v_perm_b32 v27, v103, v102, v15
  v_mfma_f32_16x16x32_bf16 v[28:31], v[20:23], a[72:75], v[28:31]
  v_perm_b32 v20, v105, v104, v12
  v_perm_b32 v21, v105, v104, v13
  v_perm_b32 v22, v105, v104, v14
  v_perm_b32 v23, v105, v104, v15
  v_mfma_f32_16x16x32_bf16 v[28:31], v[24:27], a[76:79], v[28:31]
  v_perm_b32 v24, v107, v106, v12
  v_perm_b32 v25, v107, v106, v13
  v_perm_b32 v26, v107, v106, v14
  v_perm_b32 v27, v107, v106, v15
  v_mfma_f32_16x16x32_bf16 v[28:31], v[20:23], a[80:83], v[28:31]
  v_perm_b32 v20, v109, v108, v12
  v_perm_b32 v21, v109, v108, v13
  v_perm_b32 v22, v109, v108, v14
  v_perm_b32 v23, v109, v108, v15
  v_mfma_f32_16x16x32_bf16 v[28:31], v[24:27], a[84:87], v[28:31]
  v_perm_b32 v24, v111, v110, v12
  v_perm_b32 v25, v111, v110, v13
  v_perm_b32 v26, v111, v110, v14
  v_perm_b32 v27, v111, v110, v15
  v_mfma_f32_16x16x32_bf16 v[28:31], v[20:23], a[88:91], v[28:31]
  v_perm_b32 v20, v113, v112, v12
  v_perm_b32 v21, v113, v112, v13
  v_perm_b32 v22, v113, v112, v14
  v_perm_b32 v23, v113, v112, v15
  v_mfma_f32_16x16x32_bf16 v[28:31], v[24:27], a[92:95], v[28:31]
  v_perm_b32 v24, v115, v114, v12
  v_perm_b32 v25, v115, v114, v13
  v_perm_b32 v26, v115, v114, v14
  v_perm_b32 v27, v115, v114, v15
  v_mfma_f32_16x16x32_bf16 v[28:31], v[20:23], a[96:99], v[28:31]
  v_perm_b32 v20, v117, v116, v12
  v_perm_b32 v21, v117, v116, v13
  v_perm_b32 v22, v117, v116, v14
  v_perm_b32 v23, v117, v116, v15
  v_mfma_f32_16x16x32_bf16 v[28:31], v[24:27], a[100:103], v[28:31]
  v_perm_b32 v24, v119, v118, v12
  v_perm_b32 v25, v119, v118, v13
  v_perm_b32 v26, v119, v118, v14
  v_perm_b32 v27, v119, v118, v15
  v_mfma_f32_16x16x32_bf16 v[28:31], v[20:23], a[104:107], v[28:31]
  v_perm_b32 v20, v121, v120, v12
  v_perm_b32 v21, v121, v120, v13
  v_perm_b32 v22, v121, v120, v14
  v_perm_b32 v23, v121, v120, v15
  v_mfma_f32_16x16x32_bf16 v[28:31], v[24:27], a[108:111], v[28:31]
  v_perm_b32 v24, v123, v122, v12
  v_perm_b32 v25, v123, v122, v13
  v_perm_b32 v26, v123, v122, v14
  v_perm_b32 v27, v123, v122, v15
  v_mfma_f32_16x16x32_bf16 v[28:31], v[20:23], a[112:115], v[28:31]
  v_perm_b32 v20, v125, v124, v12
  v_perm_b32 v21, v125, v124, v13
  v_perm_b32 v22, v125, v124, v14
  v_perm_b32 v23, v125, v124, v15
  v_mfma_f32_16x16x32_bf16 v[28:31], v[24:27], a[116:119], v[28:31]
  v_perm_b32 v24, v127, v126, v12
  v_perm_b32 v25, v127, v126, v13
  v_perm_b32 v26, v127, v126, v14
  v_perm_b32 v27, v127, v126, v15
  v_mfma_f32_16x16x32_bf16 v[28:31], v[20:23], a[120:123], v[28:31]
  v_perm_b32 v20, v129, v128, v12
  v_perm_b32 v21, v129, v128, v13
  v_perm_b32 v22, v129, v128, v14
  v_perm_b32 v23, v129, v128, v15
  v_mfma_f32_16x16x32_bf16 v[28:31], v[24:27], a[124:127], v[28:31]
  v_perm_b32 v24, v131, v130, v12
  v_perm_b32 v25, v131, v130, v13
  v_perm_b32 v26, v131, v130, v14
  v_perm_b32 v27, v131, v130, v15
  v_mfma_f32_16x16x32_bf16 v[28:31], v[20:23], a[128:131], v[28:31]
  v_perm_b32 v20, v133, v132, v12
  v_perm_b32 v21, v133, v132, v13
  v_perm_b32 v22, v133, v132, v14
  v_perm_b32 v23, v133, v132, v15
  v_mfma_f32_16x16x32_bf16 v[28:31], v[24:27], a[132:135], v[28:31]
  v_perm_b32 v24, v135, v134, v12
  v_perm_b32 v25, v135, v134, v13
  v_perm_b32 v26, v135, v134, v14
  v_perm_b32 v27, v135, v134, v15
  v_mfma_f32_16x16x32_bf16 v[28:31], v[20:23], a[136:139], v[28:31]
  v_perm_b32 v20, v137, v136, v12
  v_perm_b32 v21, v137, v136, v13
  v_perm_b32 v22, v137, v136, v14
  v_perm_b32 v23, v137, v136, v15
  v_mfma_f32_16x16x32_bf16 v[28:31], v[24:27], a[140:143], v[28:31]
  v_perm_b32 v24, v139, v138, v12
  v_perm_b32 v25, v139, v138, v13
  v_perm_b32 v26, v139, v138, v14
  v_perm_b32 v27, v139, v138, v15
  v_mfma_f32_16x16x32_bf16 v[28:31], v[20:23], a[144:147], v[28:31]
  v_perm_b32 v20, v141, v140, v12
  v_perm_b32 v21, v141, v140, v13
  v_perm_b32 v22, v141, v140, v14
  v_perm_b32 v23, v141, v140, v15
  v_mfma_f32_16x16x32_bf16 v[28:31], v[24:27], a[148:151], v[28:31]
  v_perm_b32 v24, v143, v142, v12
  v_perm_b32 v25, v143, v142, v13
  v_perm_b32 v26, v143, v142, v14
  v_perm_b32 v27, v143, v142, v15
  v_mfma_f32_16x16x32_bf16 v[28:31], v[20:23], a[152:155], v[28:31]
  v_perm_b32 v20, v145, v144, v12
  v_perm_b32 v21, v145, v144, v13
  v_perm_b32 v22, v145, v144, v14
  v_perm_b32 v23, v145, v144, v15
  v_mfma_f32_16x16x32_bf16 v[28:31], v[24:27], a[156:159], v[28:31]
  v_perm_b32 v24, v147, v146, v12
  v_perm_b32 v25, v147, v146, v13
  v_perm_b32 v26, v147, v146, v14
  v_perm_b32 v27, v147, v146, v15
  v_mfma_f32_16x16x32_bf16 v[28:31], v[20:23], a[160:163], v[28:31]
  v_perm_b32 v20, v149, v148, v12
  v_perm_b32 v21, v149, v148, v13
  v_perm_b32 v22, v149, v148, v14
  v_perm_b32 v23, v149, v148, v15
  v_mfma_f32_16x16x32_bf16 v[28:31], v[24:27], a[164:167], v[28:31]
  v_perm_b32 v24, v151, v150, v12
  v_perm_b32 v25, v151, v150, v13
  v_perm_b32 v26, v151, v150, v14
  v_perm_b32 v27, v151, v150, v15
  v_mfma_f32_16x16x32_bf16 v[28:31], v[20:23], a[168:171], v[28:31]
  v_perm_b32 v20, v153, v152, v12
  v_perm_b32 v21, v153, v152, v13
  v_perm_b32 v22, v153, v152, v14
  v_perm_b32 v23, v153, v152, v15
  v_mfma_f32_16x16x32_bf16 v[28:31], v[24:27], a[172:175], v[28:31]
  v_perm_b32 v24, v155, v154, v12
  v_perm_b32 v25, v155, v154, v13
  v_perm_b32 v26, v155, v154, v14
  v_perm_b32 v27, v155, v154, v15
  v_mfma_f32_16x16x32_bf16 v[28:31], v[20:23], a[176:179], v[28:31]
  v_perm_b32 v20, v157, v156, v12
  v_perm_b32 v21, v157, v156, v13
  v_perm_b32 v22, v157, v156, v14
  v_perm_b32 v23, v157, v156, v15
  v_mfma_f32_16x16x32_bf16 v[28:31], v[24:27], a[180:183], v[28:31]
  v_perm_b32 v24, v159, v158, v12
  v_perm_b32 v25, v159, v158, v13
  v_perm_b32 v26, v159, v158, v14
  v_perm_b32 v27, v159, v158, v15
  v_mfma_f32_16x16x32_bf16 v[28:31], v[20:23], a[184:187], v[28:31]
  s_nop 0
  v_mfma_f32_16x16x32_bf16 v[28:31], v[24:27], a[188:191], v[28:31]
  v_mov_b32 v7, 0xffffff00
  s_nop 6
  v_and_or_b32 v28, v28, v7, s76
  v_and_or_b32 v29, v29, v7, s77
  v_and_or_b32 v30, v30, v7, s78
  v_and_or_b32 v31, v31, v7, s79
  s_lshl_b32 s3, s83, 10
  s_cmp_lt_u32 s81, 32
  s_cselect_b32 s89, s89, 0
  s_cmp_eq_u32 s89, 0
  s_cbranch_scc1 L_far1
  buffer_store_dwordx4 v[28:31], v1, s[48:51], s3 offen
  s_branch L_near1
L_far1:
  buffer_store_dwordx4 v[28:31], v1, s[48:51], s3 offen sc1
L_near1:
L_wo:
  s_mul_i32 s3, s33, 147456
  s_mul_i32 s47, s46, 384
  s_add_u32 s3, s3, s47
  s_add_u32 s36, s12, s3
  s_addc_u32 s37, s13, 0
  s_sub_u32 s38, 4718592, s3
  s_mov_b32 s42, 0
  s_movk_i32 s3, 9216
  buffer_load_dwordx4 a[0:3], v3, s[36:39], s42 offen offset:0
  buffer_load_dwordx4 a[8:11], v3, s[36:39], s42 offen offset:128
  s_waitcnt vmcnt(1)
  buffer_load_dwordx4 a[16:19], v3, s[36:39], s42 offen offset:256
  s_add_u32 s42, s42, s3
  s_waitcnt vmcnt(1)
  buffer_load_dwordx4 a[4:7], v3, s[36:39], s42 offen offset:0
  s_waitcnt vmcnt(1)
  buffer_load_dwordx4 a[12:15], v3, s[36:39], s42 offen offset:128
  s_waitcnt vmcnt(1)
  buffer_load_dwordx4 a[20:23], v3, s[36:39], s42 offen offset:256
  s_add_u32 s42, s42, s3
  s_waitcnt vmcnt(1)
  buffer_load_dwordx4 a[24:27], v3, s[36:39], s42 offen offset:0
  s_waitcnt vmcnt(1)
  buffer_load_dwordx4 a[32:35], v3, s[36:39], s42 offen offset:128
  s_waitcnt vmcnt(1)
  buffer_load_dwordx4 a[40:43], v3, s[36:39], s42 offen offset:256
  s_add_u32 s42, s42, s3
  s_waitcnt vmcnt(1)
  buffer_load_dwordx4 a[28:31], v3, s[36:39], s42 offen offset:0
  s_waitcnt vmcnt(1)
  buffer_load_dwordx4 a[36:39], v3, s[36:39], s42 offen offset:128
  s_waitcnt vmcnt(1)
  buffer_load_dwordx4 a[44:47], v3, s[36:39], s42 offen offset:256
  s_add_u32 s42, s42, s3
  s_waitcnt vmcnt(1)
  buffer_load_dwordx4 a[48:51], v3, s[36:39], s42 offen offset:0
  s_waitcnt vmcnt(1)
  buffer_load_dwordx4 a[56:59], v3, s[36:39], s42 offen offset:128
  s_waitcnt vmcnt(1)
  buffer_load_dwordx4 a[64:67], v3, s[36:39], s42 offen offset:256
  s_add_u32 s42, s42, s3
  s_waitcnt vmcnt(1)
  buffer_load_dwordx4 a[52:55], v3, s[36:39], s42 offen offset:0
  s_waitcnt vmcnt(1)
  buffer_load_dwordx4 a[60:63], v3, s[36:39], s42 offen offset:128
  s_waitcnt vmcnt(1)
  buffer_load_dwordx4 a[68:71], v3, s[36:39], s42 offen offset:256
  s_add_u32 s42, s42, s3
  s_waitcnt vmcnt(1)
  buffer_load_dwordx4 a[72:75], v3, s[36:39], s42 offen offset:0
  s_waitcnt vmcnt(1)
  buffer_load_dwordx4 a[80:83], v3, s[36:39], s42 offen offset:128
  s_waitcnt vmcnt(1)
  buffer_load_dwordx4 a[88:91], v3, s[36:39], s42 offen offset:256
  s_add_u32 s42, s42, s3
  s_waitcnt vmcnt(1)
  buffer_load_dwordx4 a[76:79], v3, s[36:39], s42 offen offset:0
  s_waitcnt vmcnt(1)
  buffer_load_dwordx4 a[84:87], v3, s[36:39], s42 offen offset:128
  s_waitcnt vmcnt(1)
  buffer_load_dwordx4 a[92:95], v3, s[36:39], s42 offen offset:256
  s_add_u32 s42, s42, s3
  s_waitcnt vmcnt(1)
  buffer_load_dwordx4 a[96:99], v3, s[36:39], s42 offen offset:0
  s_waitcnt vmcnt(1)
  buffer_load_dwordx4 a[104:107], v3, s[36:39], s42 offen offset:128
  s_waitcnt vmcnt(1)
  buffer_load_dwordx4 a[112:115], v3, s[36:39], s42 offen offset:256
  s_add_u32 s42, s42, s3
  s_waitcnt vmcnt(1)
  buffer_load_dwordx4 a[100:103], v3, s[36:39], s42 offen offset:0
  s_waitcnt vmcnt(1)
  buffer_load_dwordx4 a[108:111], v3, s[36:39], s42 offen offset:128
  s_waitcnt vmcnt(1)
  buffer_load_dwordx4 a[116:119], v3, s[36:39], s42 offen offset:256
  s_add_u32 s42, s42, s3
  s_waitcnt vmcnt(1)
  buffer_load_dwordx4 a[120:123], v3, s[36:39], s42 offen offset:0
  s_waitcnt vmcnt(1)
  buffer_load_dwordx4 a[128:131], v3, s[36:39], s42 offen offset:128
  s_waitcnt vmcnt(1)
  buffer_load_dwordx4 a[136:139], v3, s[36:39], s42 offen offset:256
  s_add_u32 s42, s42, s3
  s_waitcnt vmcnt(1)
  buffer_load_dwordx4 a[124:127], v3, s[36:39], s42 offen offset:0
  s_waitcnt vmcnt(1)
  buffer_load_dwordx4 a[132:135], v3, s[36:39], s42 offen offset:128
  s_waitcnt vmcnt(1)
  buffer_load_dwordx4 a[140:143], v3, s[36:39], s42 offen offset:256
  s_add_u32 s42, s42, s3
  s_waitcnt vmcnt(1)
  buffer_load_dwordx4 a[144:147], v3, s[36:39], s42 offen offset:0
  s_waitcnt vmcnt(1)
  buffer_load_dwordx4 a[152:155], v3, s[36:39], s42 offen offset:128
  s_waitcnt vmcnt(1)
  buffer_load_dwordx4 a[160:163], v3, s[36:39], s42 offen offset:256
  s_add_u32 s42, s42, s3
  s_waitcnt vmcnt(1)
  buffer_load_dwordx4 a[148:151], v3, s[36:39], s42 offen offset:0
  s_waitcnt vmcnt(1)
  buffer_load_dwordx4 a[156:159], v3, s[36:39], s42 offen offset:128
  s_waitcnt vmcnt(1)
  buffer_load_dwordx4 a[164:167], v3, s[36:39], s42 offen offset:256
  s_add_u32 s42, s42, s3
  s_waitcnt vmcnt(1)
  buffer_load_dwordx4 a[168:171], v3, s[36:39], s42 offen offset:0
  s_waitcnt vmcnt(1)
  buffer_load_dwordx4 a[176:179], v3, s[36:39], s42 offen offset:128
  s_waitcnt vmcnt(1)
  buffer_load_dwordx4 a[184:187], v3, s[36:39], s42 offen offset:256
  s_add_u32 s42, s42, s3
  s_waitcnt vmcnt(1)
  buffer_load_dwordx4 a[172:175], v3, s[36:39], s42 offen offset:0
  s_waitcnt vmcnt(1)
  buffer_load_dwordx4 a[180:183], v3, s[36:39], s42 offen offset:128
  s_waitcnt vmcnt(1)
  buffer_load_dwordx4 a[188:191], v3, s[36:39], s42 offen offset:256
  s_cmp_eq_u32 s46, 1
  s_cbranch_scc1 L_h1
  s_cmp_eq_u32 s46, 2
  s_cbranch_scc1 L_hjoin
  s_mov_b32 s43, 0x400000
L_kwait:
  s_sleep 2
  ds_read_b32 v7, v17 offset:0
  s_sub_u32 s43, s43, 1
  s_waitcnt lgkmcnt(0)
  s_cbranch_scc1 L_kdone
  v_cmp_gt_u32 vcc, 1, v7
  s_cbranch_vccnz L_kwait
L_kdone:
  s_mul_i32 s88, s31, 5
  s_add_u32 s88, s88, s32
  s_and_b32 s88, s88, 31
  s_lshl_b32 s88, s88, 8
  s_add_u32 s88, s88, 1310720
  s_add_u32 s86, s28, s88
  s_addc_u32 s87, s29, 0
  s_mov_b32 s88, 1
  s_atomic_add s88, s[86:87], 0 glc
  s_waitcnt lgkmcnt(0)
  ds_read_b32 v7, v17 offset:0
  s_min_u32 s88, s88, 7
  s_mov_b32 s90, 0x0
  s_mov_b32 s91, 0x420008
  s_mov_b32 s92, 0x2d50524
  s_mov_b32 s93, 0x3ff05bb
  s_cmp_lt_u32 s88, 4
  s_cselect_b64 s[90:91], s[90:91], s[92:93]
  s_lshl_b32 s88, s88, 4
  s_lshr_b64 s[90:91], s[90:91], s88
  s_and_b32 s88, s90, 0xffff
  s_lshl_b32 s88, s88, 1
  s_waitcnt lgkmcnt(0)
  v_lshlrev_b32 v7, v7, s88
  ds_write_b32 v17, v7 offset:4
  ds_read_b128 v[64:67], v1 offset:64
  ds_read_b128 v[68:71], v1 offset:1088
  ds_read_b128 v[72:75], v1 offset:2112
  ds_read_b128 v[76:79], v1 offset:3136
  ds_read_b128 v[80:83], v1 offset:4160
  ds_read_b128 v[84:87], v1 offset:5184
  ds_read_b128 v[88:91], v1 offset:6208
  ds_read_b128 v[92:95], v1 offset:7232
  s_mov_b32 s45, 0x3e0293ee
  s_lshl_b32 s3, s44, 7
  s_add_u32 s3, s3, 720896
  s_add_u32 s48, s28, s3
  s_addc_u32 s49, s29, 0
  s_mov_b32 s50, 16
  s_waitcnt lgkmcnt(0)
  v_max_f32 v40, v64, v65
  v_max3_f32 v40, v40, v66, v67
  v_max3_f32 v40, v40, v68, v69
  v_max3_f32 v40, v40, v70, v71
  v_max3_f32 v40, v40, v72, v73
  v_max3_f32 v40, v40, v74, v75
  v_max3_f32 v40, v40, v76, v77
  v_max3_f32 v40, v40, v78, v79
  v_max3_f32 v40, v40, v80, v81
  v_max3_f32 v40, v40, v82, v83
  v_max3_f32 v40, v40, v84, v85
  v_max3_f32 v40, v40, v86, v87
  v_max3_f32 v40, v40, v88, v89
  v_max3_f32 v40, v40, v90, v91
  v_max3_f32 v40, v40, v92, v93
  v_max3_f32 v40, v40, v94, v95
  s_nop 1
  v_max_f32_dpp v40, v40, v40 row_ror:1 row_mask:0xf bank_mask:0xf
  s_nop 1
  v_max_f32_dpp v40, v40, v40 row_ror:2 row_mask:0xf bank_mask:0xf
  s_nop 1
  v_max_f32_dpp v40, v40, v40 row_ror:4 row_mask:0xf bank_mask:0xf
  s_nop 1
  v_max_f32_dpp v40, v40, v40 row_ror:8 row_mask:0xf bank_mask:0xf
  s_nop 1
  v_max_f32_dpp v40, v40, v40 row_bcast:15 row_mask:0xa bank_mask:0xf
  s_nop 1
  v_max_f32_dpp v40, v40, v40 row_bcast:31 row_mask:0xc bank_mask:0xf
  s_nop 1
  v_readlane_b32 s3, v40, 63
  v_mov_b32 v40, s45
  s_nop 0
  v_mul_f32 v40, s3, v40
  v_fma_f32 v64, v64, s45, -v40
  v_fma_f32 v65, v65, s45, -v40
  v_fma_f32 v66, v66, s45, -v40
  v_fma_f32 v67, v67, s45, -v40
  v_fma_f32 v68, v68, s45, -v40
  v_fma_f32 v69, v69, s45, -v40
  v_fma_f32 v70, v70, s45, -v40
  v_fma_f32 v71, v71, s45, -v40
  v_fma_f32 v72, v72, s45, -v40
  v_fma_f32 v73, v73, s45, -v40
  v_fma_f32 v74, v74, s45, -v40
  v_fma_f32 v75, v75, s45, -v40
  v_fma_f32 v76, v76, s45, -v40
  v_fma_f32 v77, v77, s45, -v40
  v_fma_f32 v78, v78, s45, -v40
  v_fma_f32 v79, v79, s45, -v40
  v_fma_f32 v80, v80, s45, -v40
  v_fma_f32 v81, v81, s45, -v40
  v_fma_f32 v82, v82, s45, -v40
  v_fma_f32 v83, v83, s45, -v40
  v_fma_f32 v84, v84, s45, -v40
  v_fma_f32 v85, v85, s45, -v40
  v_fma_f32 v86, v86, s45, -v40
  v_fma_f32 v87, v87, s45, -v40
  v_fma_f32 v88, v88, s45, -v40
  v_fma_f32 v89, v89, s45, -v40
  v_fma_f32 v90, v90, s45, -v40
  v_fma_f32 v91, v91, s45, -v40
  v_fma_f32 v92, v92, s45, -v40
  v_fma_f32 v93, v93, s45, -v40
  v_fma_f32 v94, v94, s45, -v40
  v_fma_f32 v95, v95, s45, -v40
  v_exp_f32 v64, v64
  v_exp_f32 v65, v65
  v_exp_f32 v66, v66
  v_exp_f32 v67, v67
  v_exp_f32 v68, v68
  v_exp_f32 v69, v69
  v_exp_f32 v70, v70
  v_exp_f32 v71, v71
  v_exp_f32 v72, v72
  v_exp_f32 v73, v73
  v_exp_f32 v74, v74
  v_exp_f32 v75, v75
  v_exp_f32 v76, v76
  v_exp_f32 v77, v77
  v_exp_f32 v78, v78
  v_exp_f32 v79, v79
  v_exp_f32 v80, v80
  v_exp_f32 v81, v81
  v_exp_f32 v82, v82
  v_exp_f32 v83, v83
  v_exp_f32 v84, v84
  v_exp_f32 v85, v85
  v_exp_f32 v86, v86
  v_exp_f32 v87, v87
  v_exp_f32 v88, v88
  v_exp_f32 v89, v89
  v_exp_f32 v90, v90
  v_exp_f32 v91, v91
  v_exp_f32 v92, v92
  v_exp_f32 v93, v93
  v_exp_f32 v94, v94
  v_exp_f32 v95, v95
  v_add_f32 v41, v64, v65
  v_add_f32 v41, v41, v66
  v_add_f32 v41, v41, v67
  v_add_f32 v41, v41, v68
  v_add_f32 v41, v41, v69
  v_add_f32 v41, v41, v70
  v_add_f32 v41, v41, v71
  v_add_f32 v41, v41, v72
  v_add_f32 v41, v41, v73
  v_add_f32 v41, v41, v74
  v_add_f32 v41, v41, v75
  v_add_f32 v41, v41, v76
  v_add_f32 v41, v41, v77
  v_add_f32 v41, v41, v78
  v_add_f32 v41, v41, v79
  v_add_f32 v41, v41, v80
  v_add_f32 v41, v41, v81
  v_add_f32 v41, v41, v82
  v_add_f32 v41, v41, v83
  v_add_f32 v41, v41, v84
  v_add_f32 v41, v41, v85
  v_add_f32 v41, v41, v86
  v_add_f32 v41, v41, v87
  v_add_f32 v41, v41, v88
  v_add_f32 v41, v41, v89
  v_add_f32 v41, v41, v90
  v_add_f32 v41, v41, v91
  v_add_f32 v41, v41, v92
  v_add_f32 v41, v41, v93
  v_add_f32 v41, v41, v94
  v_add_f32 v41, v41, v95
  s_nop 1
  v_add_f32_dpp v41, v41, v41 row_ror:1 row_mask:0xf bank_mask:0xf
  s_nop 1
  v_add_f32_dpp v41, v41, v41 row_ror:2 row_mask:0xf bank_mask:0xf
  s_nop 1
  v_add_f32_dpp v41, v41, v41 row_ror:4 row_mask:0xf bank_mask:0xf
  s_nop 1
  v_add_f32_dpp v41, v41, v41 row_ror:8 row_mask:0xf bank_mask:0xf
  s_nop 1
  v_add_f32_dpp v41, v41, v41 row_bcast:15 row_mask:0xa bank_mask:0xf
  s_nop 1
  v_add_f32_dpp v41, v41, v41 row_bcast:31 row_mask:0xc bank_mask:0xf
  s_nop 1
  v_mov_b32 v7, 0xffffff00
  v_and_b32 v42, v7, v40
  v_and_b32 v43, v7, v41
  v_sub_f32 v42, v40, v42
  v_sub_f32 v43, v41, v43
  v_mov_b32 v44, v40
  v_and_or_b32 v40, v40, v7, s76
  v_and_or_b32 v41, v41, v7, s77
  v_and_or_b32 v42, v42, v7, s78
  v_and_or_b32 v43, v43, v7, s79
  v_sub_u32 v6, 63, v0
  v_lshlrev_b32 v6, 4, v6
  s_cmp_eq_u32 s89, 0
  s_cbranch_scc1 L_far2
  buffer_store_dwordx4 v[40:43], v6, s[48:51], 0 offen
  s_branch L_near2
L_far2:
  buffer_store_dwordx4 v[40:43], v6, s[48:51], 0 offen sc1
L_near2:
  s_mov_b32 s43, 0x400000
L_mwait:
  s_sleep 4
  ds_read_b32 v7, v17 offset:0
  s_sub_u32 s43, s43, 1
  s_waitcnt lgkmcnt(0)
  s_cbranch_scc1 L_mdone
  v_cmp_gt_u32 vcc, 7, v7
  s_cbranch_vccnz L_mwait
L_mdone:
  s_andn2_b32 s3, s44, 3
  s_lshl_b32 s3, s3, 7
  s_add_u32 s3, s3, 720896
  s_add_u32 s48, s28, s3
  s_addc_u32 s49, s29, 0
  s_mov_b32 s50, 512
  v_and_b32 v6, 3, v0
  v_lshlrev_b32 v6, 7, v6
  s_mov_b32 s43, 0x40000
L_nwait:
  buffer_load_dwordx4 v[40:43], v6, s[48:51], 0 offen sc1
  s_sub_u32 s43, s43, 1
  s_waitcnt vmcnt(0)
  s_cbranch_scc1 L_ndone
  v_xor_b32 v40, s76, v40
  v_xor_b32 v41, s77, v41
  v_xor_b32 v42, s78, v42
  v_xor_b32 v43, s79, v43
  v_or_b32 v7, v40, v41
  v_or3_b32 v7, v7, v42, v43
  v_and_b32 v7, 0xff, v7
  v_cmp_ne_u32 vcc, 0, v7
  s_cbranch_vccz L_ndone
  s_sleep 16
  s_branch L_nwait
L_ndone:
  v_add_f32 v40, v40, v42
  v_add_f32 v41, v41, v43
  s_nop 0
  v_max_f32_dpp v42, v40, v40 quad_perm:[1,0,3,2] row_mask:0xf bank_mask:0xf
  s_nop 1
  v_max_f32_dpp v42, v42, v42 quad_perm:[2,3,0,1] row_mask:0xf bank_mask:0xf
  v_sub_f32 v40, v40, v42
  v_sub_f32 v44, v44, v42
  v_exp_f32 v40, v40
  v_exp_f32 v44, v44
  v_mul_f32 v41, v41, v40
  v_mul_f32 v44, v44, v19
  s_nop 0
  v_add_f32_dpp v41, v41, v41 quad_perm:[1,0,3,2] row_mask:0xf bank_mask:0xf
  s_nop 1
  v_add_f32_dpp v41, v41, v41 quad_perm:[2,3,0,1] row_mask:0xf bank_mask:0xf
  v_rcp_f32 v41, v41
  s_nop 0
  v_mul_f32 v44, v44, v41
  ds_write_b32 v17, v44 offset:20
  s_mov_b32 s43, 0x400000
L_c1wait:
  s_sleep 1
  ds_read_b32 v7, v17 offset:0
  s_sub_u32 s43, s43, 1
  s_waitcnt lgkmcnt(0)
  s_cbranch_scc1 L_c1done
  v_cmp_gt_u32 vcc, 12, v7
  s_cbranch_vccnz L_c1wait
L_c1done:
  s_mul_i32 s88, s31, 10
  s_add_u32 s88, s88, s32
  s_and_b32 s88, s88, 31
  s_lshl_b32 s88, s88, 8
  s_add_u32 s88, s88, 1318912
  s_add_u32 s86, s28, s88
  s_addc_u32 s87, s29, 0
  s_mov_b32 s88, 1
  s_atomic_add s88, s[86:87], 0 glc
  s_waitcnt lgkmcnt(0)
  ds_read_b32 v7, v17 offset:0
  s_min_u32 s88, s88, 7
  s_mov_b32 s90, 0x0
  s_mov_b32 s91, 0x210004
  s_mov_b32 s92, 0x1520092
  s_mov_b32 s93, 0xff016d
  s_cmp_lt_u32 s88, 4
  s_cselect_b64 s[90:91], s[90:91], s[92:93]
  s_lshl_b32 s88, s88, 4
  s_lshr_b64 s[90:91], s[90:91], s88
  s_and_b32 s88, s90, 0xffff
  s_lshl_b32 s88, s88, 1
  s_waitcnt lgkmcnt(0)
  v_lshlrev_b32 v7, v7, s88
  ds_write_b32 v17, v7 offset:4
  s_mov_b32 s43, 0x400000
L_c2wait:
  s_sleep 1
  ds_read_b32 v7, v17 offset:0
  s_sub_u32 s43, s43, 1
  s_waitcnt lgkmcnt(0)
  s_cbranch_scc1 L_c2done
  v_cmp_gt_u32 vcc, 21, v7
  s_cbranch_vccnz L_c2wait
L_c2done:
  s_mul_i32 s88, s31, 15
  s_add_u32 s88, s88, s32
  s_and_b32 s88, s88, 31
  s_lshl_b32 s88, s88, 8
  s_add_u32 s88, s88, 1327104
  s_add_u32 s86, s28, s88
  s_addc_u32 s87, s29, 0
  s_mov_b32 s88, 1
  s_atomic_add s88, s[86:87], 0 glc
  s_waitcnt lgkmcnt(0)
  ds_read_b32 v7, v17 offset:0
  s_min_u32 s88, s88, 7
  s_mov_b32 s90, 0x0
  s_mov_b32 s91, 0x100000
  s_mov_b32 s92, 0x15000a
  s_mov_b32 s93, 0x1f000f
  s_cmp_lt_u32 s88, 4
  s_cselect_b64 s[90:91], s[90:91], s[92:93]
  s_lshl_b32 s88, s88, 4
  s_lshr_b64 s[90:91], s[90:91], s88
  s_and_b32 s88, s90, 0xffff
  s_lshl_b32 s88, s88, 1
  s_waitcnt lgkmcnt(0)
  v_lshlrev_b32 v7, v7, s88
  v_or_b32 v7, 0x18000000, v7
  ds_write_b32 v17, v7 offset:4
  s_branch L_hjoin
L_h1:
  s_sub_u32 s45, s83, 3
  s_cmp_lt_u32 s45, 3
  s_cbranch_scc0 L_hjoin
  ds_read_b128 v[64:67], v1 offset:16384
  ds_read_b128 v[72:75], v1 offset:17408
  ds_read_b128 v[80:83], v1 offset:18432
  ds_read_b128 v[68:71], v1 offset:19456
  ds_read_b128 v[76:79], v1 offset:20480
  ds_read_b128 v[84:87], v1 offset:21504
  ds_read_b128 v[88:91], v1 offset:22528
  ds_read_b128 v[96:99], v1 offset:23552
  ds_read_b128 v[104:107], v1 offset:24576
  ds_read_b128 v[92:95], v1 offset:25600
  ds_read_b128 v[100:103], v1 offset:26624
  ds_read_b128 v[108:111], v1 offset:27648
  ds_read_b128 v[112:115], v1 offset:28672
  ds_read_b128 v[120:123], v1 offset:29696
  ds_read_b128 v[128:131], v1 offset:30720
  ds_read_b128 v[116:119], v1 offset:31744
  ds_read_b128 v[124:127], v1 offset:32768
  ds_read_b128 v[132:135], v1 offset:33792
  ds_read_b128 v[136:139], v1 offset:34816
  ds_read_b128 v[144:147], v1 offset:35840
  ds_read_b128 v[152:155], v1 offset:36864
  ds_read_b128 v[140:143], v1 offset:37888
  ds_read_b128 v[148:151], v1 offset:38912
  ds_read_b128 v[156:159], v1 offset:39936
  ds_read_b128 v[160:163], v1 offset:40960
  ds_read_b128 v[168:171], v1 offset:41984
  ds_read_b128 v[176:179], v1 offset:43008
  ds_read_b128 v[164:167], v1 offset:44032
  ds_read_b128 v[172:175], v1 offset:45056
  ds_read_b128 v[180:183], v1 offset:46080
  ds_read_b128 v[184:187], v1 offset:47104
  ds_read_b128 v[192:195], v1 offset:48128
  ds_read_b128 v[200:203], v1 offset:49152
  ds_read_b128 v[188:191], v1 offset:50176
  ds_read_b128 v[196:199], v1 offset:51200
  ds_read_b128 v[204:207], v1 offset:52224
  ds_read_b128 v[208:211], v1 offset:53248
  ds_read_b128 v[216:219], v1 offset:54272
  ds_read_b128 v[224:227], v1 offset:55296
  ds_read_b128 v[212:215], v1 offset:56320
  ds_read_b128 v[220:223], v1 offset:57344
  ds_read_b128 v[228:231], v1 offset:58368
  ds_read_b128 v[232:235], v1 offset:59392
  ds_read_b128 v[240:243], v1 offset:60416
  ds_read_b128 v[248:251], v1 offset:61440
  ds_read_b128 v[236:239], v1 offset:62464
  ds_read_b128 v[244:247], v1 offset:63488
  ds_read_b128 v[252:255], v1 offset:64512
  s_waitcnt lgkmcnt(0)
  s_mov_b32 s43, 0x40000
L_hwait:
  buffer_load_dwordx4 v[40:43], v1, s[48:51], 0 offen offset:0 sc1
  buffer_load_dwordx4 v[44:47], v1, s[48:51], 0 offen offset:1024 sc1
  buffer_load_dwordx4 v[48:51], v1, s[48:51], 0 offen offset:2048 sc1
  s_sub_u32 s43, s43, 1
  s_waitcnt vmcnt(0)
  s_cbranch_scc1 L_hdone
  v_xor_b32 v40, s76, v40
  v_xor_b32 v41, s77, v41
  v_xor_b32 v42, s78, v42
  v_xor_b32 v43, s79, v43
  v_xor_b32 v44, s76, v44
  v_xor_b32 v45, s77, v45
  v_xor_b32 v46, s78, v46
  v_xor_b32 v47, s79, v47
  v_xor_b32 v48, s76, v48
  v_xor_b32 v49, s77, v49
  v_xor_b32 v50, s78, v50
  v_xor_b32 v51, s79, v51
  v_or_b32 v7, v40, v41
  v_or3_b32 v7, v7, v42, v43
  v_or3_b32 v7, v7, v44, v45
  v_or3_b32 v7, v7, v46, v47
  v_or3_b32 v7, v7, v48, v49
  v_or3_b32 v7, v7, v50, v51
  v_and_b32 v7, 0xff, v7
  v_cmp_ne_u32 vcc, 0, v7
  s_cbranch_vccz L_hdone
  s_sleep 16
  s_branch L_hwait
L_hdone:
  v_lshlrev_b32 v28, 16, v10
  v_and_b32 v29, 0xffff0000, v10
  v_lshlrev_b32 v30, 16, v11
  v_and_b32 v31, 0xffff0000, v11
  v_add_f32 v28, v28, v40
  v_add_f32 v29, v29, v41
  v_add_f32 v30, v30, v42
  v_add_f32 v31, v31, v43
  v_add_f32 v28, v28, v44
  v_add_f32 v29, v29, v45
  v_add_f32 v30, v30, v46
  v_add_f32 v31, v31, v47
  v_add_f32 v28, v28, v48
  v_add_f32 v29, v29, v49
  v_add_f32 v30, v30, v50
  v_add_f32 v31, v31, v51
  s_mov_b32 s3, 0xbfb8aa3b
  v_mul_f32 v40, s3, abs(v28)
  v_mul_f32 v41, s3, abs(v29)
  v_mul_f32 v42, s3, abs(v30)
  v_mul_f32 v43, s3, abs(v31)
  v_exp_f32 v40, v40
  v_exp_f32 v41, v41
  v_exp_f32 v42, v42
  v_exp_f32 v43, v43
  s_nop 0
  v_mul_f32 v44, v40, v40
  v_cmp_lt_f32 vcc, 0, v28
  v_add_f32 v45, v40, v40
  s_nop 0
  v_cndmask_b32 v46, v44, 1.0, vcc
  v_cndmask_b32 v47, 1.0, v44, vcc
  v_add_f32 v46, v46, v45
  v_fma_f32 v47, v47, 2.0, v46
  v_rcp_f32 v47, v47
  v_mul_f32 v46, v46, v28
  v_mul_f32 v46, v46, v47
  v_and_b32 v47, 0xffff0000, v46
  v_sub_f32 v46, v46, v47
  v_cvt_pk_bf16_f32 v49, v46, v47
  v_mul_f32 v44, v41, v41
  v_cmp_lt_f32 vcc, 0, v29
  v_add_f32 v45, v41, v41
  s_nop 0
  v_cndmask_b32 v46, v44, 1.0, vcc
  v_cndmask_b32 v47, 1.0, v44, vcc
  v_add_f32 v46, v46, v45
  v_fma_f32 v47, v47, 2.0, v46
  v_rcp_f32 v47, v47
  v_mul_f32 v46, v46, v29
  v_mul_f32 v46, v46, v47
  v_and_b32 v47, 0xffff0000, v46
  v_sub_f32 v46, v46, v47
  v_cvt_pk_bf16_f32 v51, v46, v47
  v_mul_f32 v44, v42, v42
  v_cmp_lt_f32 vcc, 0, v30
  v_add_f32 v45, v42, v42
  s_nop 0
  v_cndmask_b32 v46, v44, 1.0, vcc
  v_cndmask_b32 v47, 1.0, v44, vcc
  v_add_f32 v46, v46, v45
  v_fma_f32 v47, v47, 2.0, v46
  v_rcp_f32 v47, v47
  v_mul_f32 v46, v46, v30
  v_mul_f32 v46, v46, v47
  v_and_b32 v47, 0xffff0000, v46
  v_sub_f32 v46, v46, v47
  v_cvt_pk_bf16_f32 v53, v46, v47
  v_mul_f32 v44, v43, v43
  v_cmp_lt_f32 vcc, 0, v31
  v_add_f32 v45, v43, v43
  s_nop 0
  v_cndmask_b32 v46, v44, 1.0, vcc
  v_cndmask_b32 v47, 1.0, v44, vcc
  v_add_f32 v46, v46, v45
  v_fma_f32 v47, v47, 2.0, v46
  v_rcp_f32 v47, v47
  v_mul_f32 v46, v46, v31
  v_mul_f32 v46, v46, v47
  v_and_b32 v47, 0xffff0000, v46
  v_sub_f32 v46, v46, v47
  v_cvt_pk_bf16_f32 v55, v46, v47
  v_lshrrev_b32 v6, 5, v0
  v_bfe_u32 v7, v0, 1, 3
  v_lshl_add_u32 v6, v6, 3, v7
  v_and_b32 v7, 1, v0
  v_lshl_add_u32 v6, v6, 2, v7
  v_bfe_u32 v7, v0, 4, 1
  v_lshl_add_u32 v6, v6, 1, v7
  v_lshlrev_b32 v6, 5, v6
  v_add_u32 v6, 65536, v6
  v_mov_b32 v48, 0
  v_mov_b32 v56, v49
  v_mov_b32 v57, 0
  v_mov_b32 v50, 0
  v_mov_b32 v58, v51
  v_mov_b32 v59, 0
  v_mov_b32 v52, 0
  v_mov_b32 v60, v53
  v_mov_b32 v61, 0
  v_mov_b32 v54, 0
  v_mov_b32 v62, v55
  v_mov_b32 v63, 0
  ds_write_b128 v6, v[56:59]
  ds_write_b128 v6, v[60:63] offset:16
  ds_write_b128 v6, v[48:51] offset:128
  ds_write_b128 v6, v[52:55] offset:144
  s_and_b32 s3, s44, 127
  s_lshl_b32 s3, s3, 10
  s_add_u32 s3, s3, 786432
  s_add_u32 s48, s28, s3
  s_addc_u32 s49, s29, 0
  s_mov_b32 s50, 768
  s_mov_b32 s45, 0
  v_add_u32 v5, 65536, v5
  s_waitcnt lgkmcnt(0)
L_m3:
  v_mov_b32 v28, 0
  v_mov_b32 v29, 0
  v_mov_b32 v30, 0
  v_mov_b32 v31, 0
  v_mov_b32 v32, 0
  v_mov_b32 v33, 0
  v_mov_b32 v34, 0
  v_mov_b32 v35, 0
  v_mov_b32 v36, 0
  v_mov_b32 v37, 0
  v_mov_b32 v38, 0
  v_mov_b32 v39, 0
  v_mov_b32 v7, 0xffffff00
  ds_read_b128 v[40:43], v5 offset:0
  ds_read_b128 v[44:47], v5 offset:256
  ds_read_b128 v[48:51], v5 offset:512
  ds_read_b128 v[52:55], v5 offset:768
  ds_read_b128 v[56:59], v5 offset:1024
  ds_read_b128 v[60:63], v5 offset:1280
  ds_read_b128 v[20:23], v5 offset:1536
  ds_read_b128 v[24:27], v5 offset:1792
  s_waitcnt lgkmcnt(7)
  v_smfmac_f32_16x16x64_bf16 v[28:31], v[40:43], v[64:71], v16
  v_smfmac_f32_16x16x64_bf16 v[32:35], v[40:43], v[72:79], v16
  v_smfmac_f32_16x16x64_bf16 v[36:39], v[40:43], v[80:87], v16
  s_waitcnt lgkmcnt(6)
  v_smfmac_f32_16x16x64_bf16 v[28:31], v[44:47], v[88:95], v16
  v_smfmac_f32_16x16x64_bf16 v[32:35], v[44:47], v[96:103], v16
  v_smfmac_f32_16x16x64_bf16 v[36:39], v[44:47], v[104:111], v16
  s_waitcnt lgkmcnt(5)
  v_smfmac_f32_16x16x64_bf16 v[28:31], v[48:51], v[112:119], v16
  v_smfmac_f32_16x16x64_bf16 v[32:35], v[48:51], v[120:127], v16
  v_smfmac_f32_16x16x64_bf16 v[36:39], v[48:51], v[128:135], v16
  s_waitcnt lgkmcnt(4)
  v_smfmac_f32_16x16x64_bf16 v[28:31], v[52:55], v[136:143], v16
  v_smfmac_f32_16x16x64_bf16 v[32:35], v[52:55], v[144:151], v16
  v_smfmac_f32_16x16x64_bf16 v[36:39], v[52:55], v[152:159], v16
  s_waitcnt lgkmcnt(3)
  v_smfmac_f32_16x16x64_bf16 v[28:31], v[56:59], v[160:167], v16
  v_smfmac_f32_16x16x64_bf16 v[32:35], v[56:59], v[168:175], v16
  v_smfmac_f32_16x16x64_bf16 v[36:39], v[56:59], v[176:183], v16
  s_waitcnt lgkmcnt(2)
  v_smfmac_f32_16x16x64_bf16 v[28:31], v[60:63], v[184:191], v16
  v_smfmac_f32_16x16x64_bf16 v[32:35], v[60:63], v[192:199], v16
  v_smfmac_f32_16x16x64_bf16 v[36:39], v[60:63], v[200:207], v16
  s_waitcnt lgkmcnt(1)
  v_smfmac_f32_16x16x64_bf16 v[28:31], v[20:23], v[208:215], v16
  v_smfmac_f32_16x16x64_bf16 v[32:35], v[20:23], v[216:223], v16
  v_smfmac_f32_16x16x64_bf16 v[36:39], v[20:23], v[224:231], v16
  s_waitcnt lgkmcnt(0)
  v_smfmac_f32_16x16x64_bf16 v[28:31], v[24:27], v[232:239], v16
  v_smfmac_f32_16x16x64_bf16 v[32:35], v[24:27], v[240:247], v16
  v_smfmac_f32_16x16x64_bf16 v[36:39], v[24:27], v[248:255], v16
  s_waitcnt lgkmcnt(0)
  s_nop 5
  v_permlane32_swap_b32 v28, v32
  v_permlane32_swap_b32 v29, v33
  v_permlane32_swap_b32 v30, v34
  v_permlane32_swap_b32 v31, v35
  v_permlane32_swap_b32 v36, v20
  v_permlane32_swap_b32 v37, v21
  v_permlane32_swap_b32 v38, v22
  v_permlane32_swap_b32 v39, v23
  v_add_f32_dpp v28, v32, v28 row_ror:8 row_mask:0xf bank_mask:0x3
  v_add_f32_dpp v29, v33, v29 row_ror:8 row_mask:0xf bank_mask:0x3
  v_add_f32_dpp v30, v34, v30 row_ror:8 row_mask:0xf bank_mask:0x3
  v_add_f32_dpp v31, v35, v31 row_ror:8 row_mask:0xf bank_mask:0x3
  v_add_f32_dpp v28, v36, v20 row_ror:8 row_mask:0xf bank_mask:0xc
  v_add_f32_dpp v29, v37, v21 row_ror:8 row_mask:0xf bank_mask:0xc
  v_add_f32_dpp v30, v38, v22 row_ror:8 row_mask:0xf bank_mask:0xc
  v_add_f32_dpp v31, v39, v23 row_ror:8 row_mask:0xf bank_mask:0xc
  v_and_or_b32 v28, v28, v7, s76
  v_and_or_b32 v29, v29, v7, s77
  v_and_or_b32 v30, v30, v7, s78
  v_and_or_b32 v31, v31, v7, s79
  s_cmp_eq_u32 s89, 0
  s_cbranch_scc1 L_far3
  buffer_store_dwordx4 v[28:31], v4, s[48:51], 0 offen
  s_branch L_near3
L_far3:
  buffer_store_dwordx4 v[28:31], v4, s[48:51], 0 offen sc1
L_near3:
  v_add_u32 v5, 2048, v5
  s_add_u32 s48, s48, 0x20000
  s_addc_u32 s49, s49, 0
  s_add_u32 s45, s45, 1
  s_cmp_lt_u32 s45, 2
  s_cbranch_scc1 L_m3
  v_and_b32 v5, 255, v5
L_hjoin:
  v_mov_b32 v12, 0
  v_mov_b32 v13, 0
  v_mov_b32 v14, 0
  v_mov_b32 v15, 0
  s_add_u32 s43, s35, 1
  s_and_b32 s43, s43, 3
  s_lshr_b32 s3, s32, 3
  s_bitcmp1_b32 s31, 0
  s_cselect_b32 s3, s3, 3
  s_cmp_eq_u32 s43, 3
  s_cselect_b32 s43, s3, s43
  s_cmp_eq_u32 s43, s46
  s_cbranch_scc0 L_nopiece
  s_mov_b32 s43, 0x400000
L_pwait:
  s_sleep 8
  ds_read_b32 v7, v17 offset:0
  s_sub_u32 s43, s43, 1
  s_waitcnt lgkmcnt(0)
  s_cbranch_scc1 L_pdone
  v_cmp_gt_u32 vcc, 17, v7
  s_cbranch_vccnz L_pwait
L_pdone:
  s_lshl_b32 s3, s44, 10
  s_add_u32 s3, s3, 786432
  s_add_u32 s48, s28, s3
  s_addc_u32 s49, s29, 0
  s_mov_b32 s50, 768
  v_min_u32 v6, 752, v4
  s_mov_b32 s43, 0x40000
L_rwait:
  buffer_load_dwordx4 v[12:15], v6, s[48:51], 0 offen sc1
  s_sub_u32 s43, s43, 1
  s_waitcnt vmcnt(0)
  s_cbranch_scc1 L_rdone
  v_xor_b32 v12, s76, v12
  v_xor_b32 v13, s77, v13
  v_xor_b32 v14, s78, v14
  v_xor_b32 v15, s79, v15
  v_or_b32 v7, v12, v13
  v_or3_b32 v7, v7, v14, v15
  v_and_b32 v7, 0xff, v7
  v_cmp_ne_u32 vcc, 0, v7
  s_cbranch_vccz L_rdone
  s_sleep 16
  s_branch L_rwait
L_rdone:
  v_sub_f32 v19, 1.0, v19
  v_mul_f32 v12, v12, v19
  v_mul_f32 v13, v13, v19
  v_mul_f32 v14, v14, v19
  v_mul_f32 v15, v15, v19
L_nopiece:
  s_mul_i32 s3, s44, 2304
  s_mul_i32 s43, s46, 768
  s_add_u32 s3, s3, s43
  s_add_u32 s56, s28, s3
  s_addc_u32 s57, s29, 0
  s_mov_b32 s58, 768
  s_waitcnt vmcnt(0) lgkmcnt(0)
  v_mov_b32 v28, 0
  v_mov_b32 v29, 0
  v_mov_b32 v30, 0
  v_mov_b32 v31, 0
  v_mov_b32 v32, 0
  v_mov_b32 v33, 0
  v_mov_b32 v34, 0
  v_mov_b32 v35, 0
  v_mov_b32 v36, 0
  v_mov_b32 v37, 0
  v_mov_b32 v38, 0
  v_mov_b32 v39, 0
  v_mov_b32 v7, 0xffffff00
  s_barrier
  ds_read_b128 v[40:43], v5 offset:8832
  ds_read_b128 v[44:47], v5 offset:9088
  ds_read_b128 v[48:51], v5 offset:9344
  ds_read_b128 v[52:55], v5 offset:9600
  ds_read_b128 v[56:59], v5 offset:9856
  ds_read_b128 v[60:63], v5 offset:10112
  ds_read_b128 v[20:23], v5 offset:10368
  ds_read_b128 v[24:27], v5 offset:10624
  ds_read_b32 v6, v17 offset:20
  s_waitcnt lgkmcnt(8)
  v_smfmac_f32_16x16x64_bf16 v[28:31], v[40:43], a[0:7], v16
  v_smfmac_f32_16x16x64_bf16 v[32:35], v[40:43], a[8:15], v16
  v_smfmac_f32_16x16x64_bf16 v[36:39], v[40:43], a[16:23], v16
  s_waitcnt lgkmcnt(7)
  v_smfmac_f32_16x16x64_bf16 v[28:31], v[44:47], a[24:31], v16
  v_smfmac_f32_16x16x64_bf16 v[32:35], v[44:47], a[32:39], v16
  v_smfmac_f32_16x16x64_bf16 v[36:39], v[44:47], a[40:47], v16
  s_waitcnt lgkmcnt(6)
  v_smfmac_f32_16x16x64_bf16 v[28:31], v[48:51], a[48:55], v16
  v_smfmac_f32_16x16x64_bf16 v[32:35], v[48:51], a[56:63], v16
  v_smfmac_f32_16x16x64_bf16 v[36:39], v[48:51], a[64:71], v16
  s_waitcnt lgkmcnt(5)
  v_smfmac_f32_16x16x64_bf16 v[28:31], v[52:55], a[72:79], v16
  v_smfmac_f32_16x16x64_bf16 v[32:35], v[52:55], a[80:87], v16
  v_smfmac_f32_16x16x64_bf16 v[36:39], v[52:55], a[88:95], v16
  s_waitcnt lgkmcnt(4)
  v_smfmac_f32_16x16x64_bf16 v[28:31], v[56:59], a[96:103], v16
  v_smfmac_f32_16x16x64_bf16 v[32:35], v[56:59], a[104:111], v16
  v_smfmac_f32_16x16x64_bf16 v[36:39], v[56:59], a[112:119], v16
  s_waitcnt lgkmcnt(3)
  v_smfmac_f32_16x16x64_bf16 v[28:31], v[60:63], a[120:127], v16
  v_smfmac_f32_16x16x64_bf16 v[32:35], v[60:63], a[128:135], v16
  v_smfmac_f32_16x16x64_bf16 v[36:39], v[60:63], a[136:143], v16
  s_waitcnt lgkmcnt(2)
  v_smfmac_f32_16x16x64_bf16 v[28:31], v[20:23], a[144:151], v16
  v_smfmac_f32_16x16x64_bf16 v[32:35], v[20:23], a[152:159], v16
  v_smfmac_f32_16x16x64_bf16 v[36:39], v[20:23], a[160:167], v16
  s_waitcnt lgkmcnt(1)
  v_smfmac_f32_16x16x64_bf16 v[28:31], v[24:27], a[168:175], v16
  v_smfmac_f32_16x16x64_bf16 v[32:35], v[24:27], a[176:183], v16
  v_smfmac_f32_16x16x64_bf16 v[36:39], v[24:27], a[184:191], v16
  s_waitcnt lgkmcnt(0)
  s_nop 5
  v_permlane32_swap_b32 v28, v32
  v_permlane32_swap_b32 v29, v33
  v_permlane32_swap_b32 v30, v34
  v_permlane32_swap_b32 v31, v35
  v_permlane32_swap_b32 v36, v20
  v_permlane32_swap_b32 v37, v21
  v_permlane32_swap_b32 v38, v22
  v_permlane32_swap_b32 v39, v23
  v_add_f32_dpp v28, v32, v28 row_ror:8 row_mask:0xf bank_mask:0x3
  v_add_f32_dpp v29, v33, v29 row_ror:8 row_mask:0xf bank_mask:0x3
  v_add_f32_dpp v30, v34, v30 row_ror:8 row_mask:0xf bank_mask:0x3
  v_add_f32_dpp v31, v35, v31 row_ror:8 row_mask:0xf bank_mask:0x3
  v_add_f32_dpp v28, v36, v20 row_ror:8 row_mask:0xf bank_mask:0xc
  v_add_f32_dpp v29, v37, v21 row_ror:8 row_mask:0xf bank_mask:0xc
  v_add_f32_dpp v30, v38, v22 row_ror:8 row_mask:0xf bank_mask:0xc
  v_add_f32_dpp v31, v39, v23 row_ror:8 row_mask:0xf bank_mask:0xc
  v_fma_f32 v28, v28, v6, v12
  v_fma_f32 v29, v29, v6, v13
  v_fma_f32 v30, v30, v6, v14
  v_fma_f32 v31, v31, v6, v15
  v_and_or_b32 v28, v28, v7, s76
  v_and_or_b32 v29, v29, v7, s77
  v_and_or_b32 v30, v30, v7, s78
  v_and_or_b32 v31, v31, v7, s79
  buffer_store_dwordx4 v[28:31], v4, s[56:59], 0 offen sc1
  s_waitcnt vmcnt(0)
  s_barrier
  s_endpgm
L_codeend:
.section .rodata,"a"
.p2align 6
.amdhsa_kernel gated_mix__mha_block_cached__dense_activation_mish__decode_kernel
  .amdhsa_next_free_vgpr 512
  .amdhsa_next_free_sgpr 96
  .amdhsa_accum_offset 256
  .amdhsa_group_segment_fixed_size 0
  .amdhsa_kernarg_size 104
  .amdhsa_user_sgpr_count 2
  .amdhsa_user_sgpr_kernarg_segment_ptr 1
  .amdhsa_system_sgpr_workgroup_id_x 1
.end_amdhsa_kernel
```
